```python
import torch

def _softmax(x, axis=-1):
    return torch.softmax(x, dim=axis)

def _gelu(x):
    return torch.nn.functional.gelu(x, approximate='tanh')

def _silu(x):
    return torch.nn.functional.silu(x)

def _sigmoid(x):
    return torch.sigmoid(x)

def _layernorm(x, axis=-1, eps=1e-05):
    m = x.mean(dim=axis, keepdim=True)
    v = x.var(dim=axis, keepdim=True, unbiased=False)
    return (x - m) / torch.sqrt(v + eps)

def _scatter_add(tgt, idx, src, axis=0):
    return tgt.clone().index_add_(axis, idx, src)

def _segment_sum(src, seg, n):
    out = torch.zeros((n,) + src.shape[1:], dtype=src.dtype)
    return out.index_add_(0, seg, src)

def _pad(x, pw):
    flat = tuple((v for pair in reversed(pw) for v in pair))
    return torch.nn.functional.pad(x, flat)
kernel_name = 'adaLN_cond__gqa_block_cached__geglu_ffn__decode'

def setup_inputs():

    _w = lambda a: (lambda t: t.to(torch.bfloat16) if t.is_floating_point() else t)(torch.as_tensor(a))

    def _A_setup():
        B, Sq, D = (1, 1, 576)
        Hq, Hkv, Sk, Dh = (32, 16, 32768, 128)
        assert Hq % Hkv == 0, (Hq, Hkv)
        return {'x': _w((lambda *s: torch.randn(*s, dtype=torch.bfloat16) * 0.1)(B, Sq, D)), 'k_cache': _w((lambda *s: torch.randn(*s, dtype=torch.bfloat16) * 0.8)(B, Hkv, Sk, Dh)), 'v_cache': _w((lambda *s: torch.randn(*s, dtype=torch.bfloat16) * 1.6)(B, Hkv, Sk, Dh)), 'wq': _w((lambda *s: torch.randn(*s, dtype=torch.bfloat16) * 0.8)(D, Hq * Dh) * D ** (-0.5)), 'wo': _w((lambda *s: torch.randn(*s, dtype=torch.bfloat16) * 1.6)(Hq * Dh, D) * (Hq * Dh) ** (-0.5))}
    _A_in = _A_setup()

    def _B_setup():
        B, S, D, F = (1, 1, 576, 4608)
        return {'x': _w((lambda *s: torch.randn(*s, dtype=torch.bfloat16) * 0.1)(B, S, D)), 'w_gate': _w((lambda *s: torch.randn(*s, dtype=torch.bfloat16) * 0.4)(D, F)), 'w_up': _w((lambda *s: torch.randn(*s, dtype=torch.bfloat16) * 0.4)(D, F)), 'w_down': _w((lambda *s: torch.randn(*s, dtype=torch.bfloat16) * 0.4)(F, D))}
    _B_in = _B_setup()
    return {'A_x': _A_in['x'], 'A_k_cache': _A_in['k_cache'], 'A_v_cache': _A_in['v_cache'], 'A_wq': _A_in['wq'], 'A_wo': _A_in['wo'], 'B_x': _B_in['x'], 'B_w_gate': _B_in['w_gate'], 'B_w_up': _B_in['w_up'], 'B_w_down': _B_in['w_down'], 'c': _w((lambda *s: torch.randn(*s, dtype=torch.bfloat16) * 0.4)(1, 576) * 8.0), 'w_mod': _w((lambda *s: torch.randn(*s, dtype=torch.bfloat16) * 0.4)(576, 6 * 576) * 576 ** (-0.5) * 8.0)}

def reference(A_x, A_k_cache, A_v_cache, A_wq, A_wo, B_x, B_w_gate, B_w_up, B_w_down, c, w_mod):

    def _A_ref(x, k_cache, v_cache, wq, wo):
        B, Sq, D = x.shape
        Hq, Dh = (32, 128)
        Hkv = k_cache.shape[1]
        rep = Hq // Hkv
        q = (lambda x, *d: x.permute(*d))((x @ wq).reshape(B, Sq, Hq, Dh), 0, 2, 1, 3)
        k = (lambda x, n, axis: torch.repeat_interleave(x, n, dim=axis))(k_cache, rep, axis=1)
        v = (lambda x, n, axis: torch.repeat_interleave(x, n, dim=axis))(v_cache, rep, axis=1)
        scores = torch.einsum('bhqd,bhkd->bhqk', q, k) * Dh ** (-0.5)
        p = _softmax(scores, axis=-1)
        o = torch.einsum('bhqk,bhkd->bhqd', p, v)
        return (lambda x, *d: x.permute(*d))(o, 0, 2, 1, 3).reshape(B, Sq, Hq * Dh) @ wo

    def _B_ref(x, w_gate, w_up, w_down):
        return _gelu(x @ w_gate) * (x @ w_up) @ w_down
    x = A_x
    mod = (_silu(c) @ w_mod).reshape(c.shape[0], 6, 1, -1)
    sa, ca, ga, sb, cb, gb = (mod[:, 0].clone(), mod[:, 1].clone(), mod[:, 2].clone(), mod[:, 3].clone(), mod[:, 4].clone(), mod[:, 5].clone())
    h = _layernorm(x, axis=-1) * (1 + ca) + sa
    x = x + ga * _A_ref(h, A_k_cache, A_v_cache, A_wq, A_wo)
    h = _layernorm(x, axis=-1) * (1 + cb) + sb
    x = x + gb * _B_ref(h, B_w_gate, B_w_up, B_w_down)
    return x
```

```asm
; @launch grid=(256,1,1) block=(768,1,1) lds=149504
.amdgcn_target "amdgcn-amd-amdhsa--gfx950"
.text
.globl adaLN_cond__gqa_block_cached__geglu_ffn__decode_kernel
.p2align 8
.type adaLN_cond__gqa_block_cached__geglu_ffn__decode_kernel,@function
adaLN_cond__gqa_block_cached__geglu_ffn__decode_kernel:
  s_cmp_ge_u32 s2, 256
  s_cbranch_scc1 L_END
  s_load_dwordx2 s[8:9], s[0:1], 8
  s_load_dwordx2 s[12:13], s[0:1], 16
  s_load_dwordx2 s[16:17], s[0:1], 104
  s_getpc_b64 s[88:89]
CPC_1:
  v_lshlrev_b32 v36, 7, v0
  v_min_u32 v36, L_END-CPC_1, v36
  v_cmp_gt_u32 vcc, L_END-CPC_1, v36
  s_nop 3
  s_mov_b64 exec, vcc
  s_cbranch_execz CPF_2
  global_load_dword v37, v36, s[88:89]
CPF_2:
  s_mov_b64 exec, -1
  v_lshrrev_b32 v1, 6, v0
  v_and_b32 v0, 63, v0
  v_readfirstlane_b32 s3, v1
  s_mov_b32 s10, 0x8000000
  s_mov_b32 s11, 0x20000
  s_mov_b32 s14, 0x8000000
  s_mov_b32 s15, 0x20000
  s_mov_b32 s18, 8388608
  s_mov_b32 s19, 0x20000
  s_mov_b32 s95, 0
  s_mov_b32 s99, s2
  s_cmp_ge_u32 s3, 8
  s_cbranch_scc1 L_AUX
  v_and_b32 v3, 15, v0
  v_lshrrev_b32 v4, 4, v0
  v_lshrrev_b32 v5, 2, v3
  v_and_b32 v6, 3, v0
  v_lshlrev_b32 v1, 8, v5
  v_lshl_add_u32 v1, v6, 6, v1
  v_lshl_add_u32 v1, v4, 4, v1
  v_lshlrev_b32 v2, 4, v0
  s_lshl_b32 s4, s99, 19
  s_lshl_b32 s5, s3, 12
  s_add_u32 s4, s4, s5
  v_mov_b32 v7, 0
  v_cmp_eq_u32 vcc, 0, v6
  s_nop 1
  v_cndmask_b32 v32, 0, 1.0, vcc
  v_cmp_eq_u32 vcc, 1, v6
  s_nop 1
  v_cndmask_b32 v33, 0, 1.0, vcc
  v_cmp_eq_u32 vcc, 2, v6
  s_nop 1
  v_cndmask_b32 v34, 0, 1.0, vcc
  v_cmp_eq_u32 vcc, 3, v6
  s_nop 1
  v_cndmask_b32 v35, 0, 1.0, vcc
  v_and_b32 v8, 1, v5
  v_lshlrev_b32 v9, 8, v8
  v_lshl_add_u32 v9, v6, 6, v9
  v_lshl_add_u32 v9, v4, 4, v9
  s_lshl_b32 s6, s3, 2
  v_add_u32 v10, s6, v4
  v_lshl_add_u32 v10, v8, 5, v10
  v_lshlrev_b32 v10, 3, v10
  v_lshlrev_b32 v11, 3, v8
  v_and_b32 v12, 1, v4
  v_lshlrev_b32 v12, 9, v12
  v_lshl_add_u32 v12, v3, 5, v12
  v_lshrrev_b32 v13, 1, v4
  v_lshl_add_u32 v12, v13, 4, v12
  s_lshl_b32 s6, s3, 10
  v_add_u32 v12, s6, v12
  v_lshrrev_b32 v13, 1, v6
  v_lshrrev_b32 v14, 3, v3
  v_lshl_add_u32 v13, v14, 1, v13
  v_and_b32 v14, 1, v0
  v_cmp_eq_u32 vcc, 1, v14
  v_mov_b32 v15, 0xffff
  v_mov_b32 v16, 0xffff0000
  v_cndmask_b32 v15, v15, v16, vcc
  v_cmp_eq_u32 vcc, 0, v13
  s_nop 1
  v_cndmask_b32 v20, 0, v15, vcc
  v_cmp_eq_u32 vcc, 1, v13
  s_nop 1
  v_cndmask_b32 v21, 0, v15, vcc
  v_cmp_eq_u32 vcc, 2, v13
  s_nop 1
  v_cndmask_b32 v22, 0, v15, vcc
  v_cmp_eq_u32 vcc, 3, v13
  s_nop 1
  v_cndmask_b32 v23, 0, v15, vcc
  v_mov_b32 v24, 0
  v_mov_b32 v25, 0
  v_mov_b32 v26, 0
  v_mov_b32 v27, 0
  s_mul_i32 s22, s3, 12288
  v_add_u32 v18, s22, v2
  s_add_u32 s22, s22, 29184
  s_mov_b32 s21, 1
  s_sub_u32 s23, s2, 144
  s_cmp_lt_u32 s23, 82
  s_cselect_b32 s21, 0, s21
  s_sub_u32 s23, s2, 244
  s_cmp_lt_u32 s23, 8
  s_cselect_b32 s21, 0, s21
  s_cmp_eq_u32 s21, 0
  s_cselect_b64 s[44:45], 0, -1
  s_mov_b32 s7, 0x3db504f3
  s_mov_b32 s6, 0x3fb8aa3b
  s_mov_b32 s20, 0
  s_cmp_lt_u32 s2, 144
  s_cbranch_scc1 L_S_NOEB
  s_cmp_lt_u32 s2, 226
  s_cbranch_scc0 L_S_NOEB
  s_mov_b32 s20, 1
  s_barrier
L_S_NOEB:
  s_waitcnt lgkmcnt(0)
  s_add_u32 s5, s4, 0
  buffer_load_dwordx4 v[72:75], v1, s[8:11], s5 offen offset:0 nt
  buffer_load_dwordx4 v[76:79], v1, s[8:11], s5 offen offset:1024 nt
  buffer_load_dwordx4 v[80:83], v1, s[8:11], s5 offen offset:2048 nt
  s_cmp_eq_u32 s20, 1
  s_cbranch_scc1 L_S_NOLB
  s_barrier
L_S_NOLB:
  s_waitcnt vmcnt(2)
  buffer_load_dwordx4 v[84:87], v1, s[8:11], s5 offen offset:3072 nt
  s_waitcnt vmcnt(2)
  s_add_u32 s5, s4, 32768
  buffer_load_dwordx4 v[88:91], v1, s[8:11], s5 offen offset:0 nt
  s_waitcnt vmcnt(2)
  buffer_load_dwordx4 v[92:95], v1, s[8:11], s5 offen offset:1024 nt
  s_waitcnt vmcnt(2)
  buffer_load_dwordx4 v[96:99], v1, s[8:11], s5 offen offset:2048 nt
  s_waitcnt vmcnt(2)
  buffer_load_dwordx4 v[100:103], v1, s[8:11], s5 offen offset:3072 nt
  s_waitcnt vmcnt(2)
  s_add_u32 s5, s4, 65536
  buffer_load_dwordx4 v[104:107], v1, s[8:11], s5 offen offset:0 nt
  s_waitcnt vmcnt(2)
  buffer_load_dwordx4 v[108:111], v1, s[8:11], s5 offen offset:1024 nt
  s_waitcnt vmcnt(2)
  buffer_load_dwordx4 v[112:115], v1, s[8:11], s5 offen offset:2048 nt
  s_waitcnt vmcnt(2)
  buffer_load_dwordx4 v[116:119], v1, s[8:11], s5 offen offset:3072 nt
  s_waitcnt vmcnt(2)
  s_add_u32 s5, s4, 98304
  buffer_load_dwordx4 v[120:123], v1, s[8:11], s5 offen offset:0 nt
  s_waitcnt vmcnt(2)
  buffer_load_dwordx4 v[124:127], v1, s[8:11], s5 offen offset:1024 nt
  s_waitcnt vmcnt(2)
  buffer_load_dwordx4 v[128:131], v1, s[8:11], s5 offen offset:2048 nt
  s_waitcnt vmcnt(2)
  buffer_load_dwordx4 v[132:135], v1, s[8:11], s5 offen offset:3072 nt
  s_mov_b64 exec, 1
  v_mov_b32 v16, 1
  ds_add_u32 v7, v16 offset:32
  s_mov_b64 exec, -1
  s_waitcnt vmcnt(2)
  s_add_u32 s5, s4, 131072
  buffer_load_dwordx4 v[136:139], v1, s[8:11], s5 offen offset:0 nt
  s_waitcnt vmcnt(2)
  buffer_load_dwordx4 v[140:143], v1, s[8:11], s5 offen offset:1024 nt
  s_waitcnt vmcnt(2)
  buffer_load_dwordx4 v[144:147], v1, s[8:11], s5 offen offset:2048 nt
  s_waitcnt vmcnt(2)
  buffer_load_dwordx4 v[148:151], v1, s[8:11], s5 offen offset:3072 nt
  s_waitcnt vmcnt(2)
  s_add_u32 s5, s4, 163840
  buffer_load_dwordx4 v[152:155], v1, s[8:11], s5 offen offset:0 nt
  s_waitcnt vmcnt(2)
  buffer_load_dwordx4 v[156:159], v1, s[8:11], s5 offen offset:1024 nt
  s_waitcnt vmcnt(2)
  buffer_load_dwordx4 v[160:163], v1, s[8:11], s5 offen offset:2048 nt
  s_waitcnt vmcnt(2)
  buffer_load_dwordx4 v[164:167], v1, s[8:11], s5 offen offset:3072 nt
  s_waitcnt vmcnt(2)
  s_add_u32 s5, s4, 196608
  s_add_u32 m0, s22, 0
  s_nop 0
  buffer_load_dwordx4 v1, s[8:11], s5 offen offset:0 nt lds
  s_waitcnt vmcnt(2)
  buffer_load_dwordx4 v1, s[8:11], s5 offen offset:1024 nt lds
  s_waitcnt vmcnt(2)
  buffer_load_dwordx4 v1, s[8:11], s5 offen offset:2048 nt lds
  s_waitcnt vmcnt(2)
  buffer_load_dwordx4 v1, s[8:11], s5 offen offset:3072 nt lds
  s_waitcnt vmcnt(2)
  s_add_u32 s5, s4, 229376
  s_add_u32 m0, s22, 4096
  s_nop 0
  buffer_load_dwordx4 v1, s[8:11], s5 offen offset:0 nt lds
  s_waitcnt vmcnt(2)
  buffer_load_dwordx4 v1, s[8:11], s5 offen offset:1024 nt lds
  s_waitcnt vmcnt(2)
  buffer_load_dwordx4 v1, s[8:11], s5 offen offset:2048 nt lds
  s_waitcnt vmcnt(2)
  buffer_load_dwordx4 v1, s[8:11], s5 offen offset:3072 nt lds
  s_waitcnt vmcnt(2)
  s_add_u32 s5, s4, 262144
  s_add_u32 m0, s22, 8192
  s_nop 0
  buffer_load_dwordx4 v1, s[8:11], s5 offen offset:0 nt lds
  s_waitcnt vmcnt(2)
  buffer_load_dwordx4 v1, s[8:11], s5 offen offset:1024 nt lds
  s_waitcnt vmcnt(2)
  buffer_load_dwordx4 v1, s[8:11], s5 offen offset:2048 nt lds
  s_waitcnt vmcnt(2)
  buffer_load_dwordx4 v1, s[8:11], s5 offen offset:3072 nt lds
  s_mov_b32 s90, 40000
SP_3:
  ds_read_b32 v13, v7 offset:0
  s_waitcnt lgkmcnt(0)
  v_readfirstlane_b32 s91, v13
  s_nop 3
  s_cmp_eq_u32 s91, 1
  s_cbranch_scc1 SPO_4
  s_sleep 1
  s_sub_u32 s90, s90, 1
  s_cbranch_scc0 SP_3
  s_or_b32 s95, s95, 2
SPO_4:
  ds_read_b128 v[52:55], v9 offset:256
  s_waitcnt lgkmcnt(0)
  v_mfma_f32_16x16x32_bf16 v[36:39], v[72:75], v[52:55], 0
  v_mfma_f32_16x16x32_bf16 v[40:43], v[76:79], v[52:55], 0
  v_mfma_f32_16x16x32_bf16 v[44:47], v[80:83], v[52:55], 0
  v_mfma_f32_16x16x32_bf16 v[48:51], v[84:87], v[52:55], 0
  s_nop 4
  v_mul_f32_dpp v28, v36, v32 quad_perm:[0,0,0,0] row_mask:0xf bank_mask:0xf
  v_mul_f32_dpp v29, v37, v32 quad_perm:[1,1,1,1] row_mask:0xf bank_mask:0xf
  v_mul_f32_dpp v30, v38, v32 quad_perm:[2,2,2,2] row_mask:0xf bank_mask:0xf
  v_mul_f32_dpp v31, v39, v32 quad_perm:[3,3,3,3] row_mask:0xf bank_mask:0xf
  v_fmac_f32_dpp v28, v40, v33 quad_perm:[0,0,0,0] row_mask:0xf bank_mask:0xf
  v_fmac_f32_dpp v29, v41, v33 quad_perm:[1,1,1,1] row_mask:0xf bank_mask:0xf
  v_fmac_f32_dpp v30, v42, v33 quad_perm:[2,2,2,2] row_mask:0xf bank_mask:0xf
  v_fmac_f32_dpp v31, v43, v33 quad_perm:[3,3,3,3] row_mask:0xf bank_mask:0xf
  v_fmac_f32_dpp v28, v44, v34 quad_perm:[0,0,0,0] row_mask:0xf bank_mask:0xf
  v_fmac_f32_dpp v29, v45, v34 quad_perm:[1,1,1,1] row_mask:0xf bank_mask:0xf
  v_fmac_f32_dpp v30, v46, v34 quad_perm:[2,2,2,2] row_mask:0xf bank_mask:0xf
  v_fmac_f32_dpp v31, v47, v34 quad_perm:[3,3,3,3] row_mask:0xf bank_mask:0xf
  v_fmac_f32_dpp v28, v48, v35 quad_perm:[0,0,0,0] row_mask:0xf bank_mask:0xf
  v_fmac_f32_dpp v29, v49, v35 quad_perm:[1,1,1,1] row_mask:0xf bank_mask:0xf
  v_fmac_f32_dpp v30, v50, v35 quad_perm:[2,2,2,2] row_mask:0xf bank_mask:0xf
  v_fmac_f32_dpp v31, v51, v35 quad_perm:[3,3,3,3] row_mask:0xf bank_mask:0xf
  v_add_f32 v28, v28, v29
  v_add_f32 v30, v30, v31
  v_add_f32 v28, v28, v30
  v_cvt_pk_bf16_f32 v28, 0, v28
  v_mul_f32 v28, s7, v28
  v_cvt_pk_bf16_f32 v56, 0, v28
  s_mov_b64 vcc, s[44:45]
  s_cbranch_vccz RW_5
  s_waitcnt vmcnt(2)
RW_5:
  s_add_u32 s5, s4, 294912
  buffer_load_dwordx4 v[72:75], v1, s[8:11], s5 offen offset:0 nt
  v_mfma_f32_16x16x32_bf16 v[36:39], v[88:91], v[52:55], 0
  v_mfma_f32_16x16x32_bf16 v[40:43], v[92:95], v[52:55], 0
  v_mfma_f32_16x16x32_bf16 v[44:47], v[96:99], v[52:55], 0
  v_mfma_f32_16x16x32_bf16 v[48:51], v[100:103], v[52:55], 0
  s_nop 4
  v_mul_f32_dpp v28, v36, v32 quad_perm:[0,0,0,0] row_mask:0xf bank_mask:0xf
  v_mul_f32_dpp v29, v37, v32 quad_perm:[1,1,1,1] row_mask:0xf bank_mask:0xf
  v_mul_f32_dpp v30, v38, v32 quad_perm:[2,2,2,2] row_mask:0xf bank_mask:0xf
  v_mul_f32_dpp v31, v39, v32 quad_perm:[3,3,3,3] row_mask:0xf bank_mask:0xf
  v_fmac_f32_dpp v28, v40, v33 quad_perm:[0,0,0,0] row_mask:0xf bank_mask:0xf
  v_fmac_f32_dpp v29, v41, v33 quad_perm:[1,1,1,1] row_mask:0xf bank_mask:0xf
  v_fmac_f32_dpp v30, v42, v33 quad_perm:[2,2,2,2] row_mask:0xf bank_mask:0xf
  v_fmac_f32_dpp v31, v43, v33 quad_perm:[3,3,3,3] row_mask:0xf bank_mask:0xf
  v_fmac_f32_dpp v28, v44, v34 quad_perm:[0,0,0,0] row_mask:0xf bank_mask:0xf
  v_fmac_f32_dpp v29, v45, v34 quad_perm:[1,1,1,1] row_mask:0xf bank_mask:0xf
  v_fmac_f32_dpp v30, v46, v34 quad_perm:[2,2,2,2] row_mask:0xf bank_mask:0xf
  v_fmac_f32_dpp v31, v47, v34 quad_perm:[3,3,3,3] row_mask:0xf bank_mask:0xf
  v_fmac_f32_dpp v28, v48, v35 quad_perm:[0,0,0,0] row_mask:0xf bank_mask:0xf
  v_fmac_f32_dpp v29, v49, v35 quad_perm:[1,1,1,1] row_mask:0xf bank_mask:0xf
  v_fmac_f32_dpp v30, v50, v35 quad_perm:[2,2,2,2] row_mask:0xf bank_mask:0xf
  v_fmac_f32_dpp v31, v51, v35 quad_perm:[3,3,3,3] row_mask:0xf bank_mask:0xf
  v_add_f32 v28, v28, v29
  v_add_f32 v30, v30, v31
  v_add_f32 v28, v28, v30
  v_cvt_pk_bf16_f32 v28, 0, v28
  v_mul_f32 v28, s7, v28
  v_cvt_pk_bf16_f32 v57, 0, v28
  s_waitcnt vmcnt(3)
  s_cbranch_vccz RW_6
  s_waitcnt vmcnt(2)
RW_6:
  buffer_load_dwordx4 v[76:79], v1, s[8:11], s5 offen offset:1024 nt
  v_mfma_f32_16x16x32_bf16 v[36:39], v[104:107], v[52:55], 0
  v_mfma_f32_16x16x32_bf16 v[40:43], v[108:111], v[52:55], 0
  v_mfma_f32_16x16x32_bf16 v[44:47], v[112:115], v[52:55], 0
  v_mfma_f32_16x16x32_bf16 v[48:51], v[116:119], v[52:55], 0
  s_nop 4
  v_mul_f32_dpp v28, v36, v32 quad_perm:[0,0,0,0] row_mask:0xf bank_mask:0xf
  v_mul_f32_dpp v29, v37, v32 quad_perm:[1,1,1,1] row_mask:0xf bank_mask:0xf
  v_mul_f32_dpp v30, v38, v32 quad_perm:[2,2,2,2] row_mask:0xf bank_mask:0xf
  v_mul_f32_dpp v31, v39, v32 quad_perm:[3,3,3,3] row_mask:0xf bank_mask:0xf
  v_fmac_f32_dpp v28, v40, v33 quad_perm:[0,0,0,0] row_mask:0xf bank_mask:0xf
  v_fmac_f32_dpp v29, v41, v33 quad_perm:[1,1,1,1] row_mask:0xf bank_mask:0xf
  v_fmac_f32_dpp v30, v42, v33 quad_perm:[2,2,2,2] row_mask:0xf bank_mask:0xf
  v_fmac_f32_dpp v31, v43, v33 quad_perm:[3,3,3,3] row_mask:0xf bank_mask:0xf
  v_fmac_f32_dpp v28, v44, v34 quad_perm:[0,0,0,0] row_mask:0xf bank_mask:0xf
  v_fmac_f32_dpp v29, v45, v34 quad_perm:[1,1,1,1] row_mask:0xf bank_mask:0xf
  v_fmac_f32_dpp v30, v46, v34 quad_perm:[2,2,2,2] row_mask:0xf bank_mask:0xf
  v_fmac_f32_dpp v31, v47, v34 quad_perm:[3,3,3,3] row_mask:0xf bank_mask:0xf
  v_fmac_f32_dpp v28, v48, v35 quad_perm:[0,0,0,0] row_mask:0xf bank_mask:0xf
  v_fmac_f32_dpp v29, v49, v35 quad_perm:[1,1,1,1] row_mask:0xf bank_mask:0xf
  v_fmac_f32_dpp v30, v50, v35 quad_perm:[2,2,2,2] row_mask:0xf bank_mask:0xf
  v_fmac_f32_dpp v31, v51, v35 quad_perm:[3,3,3,3] row_mask:0xf bank_mask:0xf
  v_add_f32 v28, v28, v29
  v_add_f32 v30, v30, v31
  v_add_f32 v28, v28, v30
  v_cvt_pk_bf16_f32 v28, 0, v28
  v_mul_f32 v28, s7, v28
  v_cvt_pk_bf16_f32 v58, 0, v28
  s_waitcnt vmcnt(3)
  s_cbranch_vccz RW_7
  s_waitcnt vmcnt(2)
RW_7:
  buffer_load_dwordx4 v[80:83], v1, s[8:11], s5 offen offset:2048 nt
  v_mfma_f32_16x16x32_bf16 v[36:39], v[120:123], v[52:55], 0
  v_mfma_f32_16x16x32_bf16 v[40:43], v[124:127], v[52:55], 0
  v_mfma_f32_16x16x32_bf16 v[44:47], v[128:131], v[52:55], 0
  v_mfma_f32_16x16x32_bf16 v[48:51], v[132:135], v[52:55], 0
  s_nop 4
  v_mul_f32_dpp v28, v36, v32 quad_perm:[0,0,0,0] row_mask:0xf bank_mask:0xf
  v_mul_f32_dpp v29, v37, v32 quad_perm:[1,1,1,1] row_mask:0xf bank_mask:0xf
  v_mul_f32_dpp v30, v38, v32 quad_perm:[2,2,2,2] row_mask:0xf bank_mask:0xf
  v_mul_f32_dpp v31, v39, v32 quad_perm:[3,3,3,3] row_mask:0xf bank_mask:0xf
  v_fmac_f32_dpp v28, v40, v33 quad_perm:[0,0,0,0] row_mask:0xf bank_mask:0xf
  v_fmac_f32_dpp v29, v41, v33 quad_perm:[1,1,1,1] row_mask:0xf bank_mask:0xf
  v_fmac_f32_dpp v30, v42, v33 quad_perm:[2,2,2,2] row_mask:0xf bank_mask:0xf
  v_fmac_f32_dpp v31, v43, v33 quad_perm:[3,3,3,3] row_mask:0xf bank_mask:0xf
  v_fmac_f32_dpp v28, v44, v34 quad_perm:[0,0,0,0] row_mask:0xf bank_mask:0xf
  v_fmac_f32_dpp v29, v45, v34 quad_perm:[1,1,1,1] row_mask:0xf bank_mask:0xf
  v_fmac_f32_dpp v30, v46, v34 quad_perm:[2,2,2,2] row_mask:0xf bank_mask:0xf
  v_fmac_f32_dpp v31, v47, v34 quad_perm:[3,3,3,3] row_mask:0xf bank_mask:0xf
  v_fmac_f32_dpp v28, v48, v35 quad_perm:[0,0,0,0] row_mask:0xf bank_mask:0xf
  v_fmac_f32_dpp v29, v49, v35 quad_perm:[1,1,1,1] row_mask:0xf bank_mask:0xf
  v_fmac_f32_dpp v30, v50, v35 quad_perm:[2,2,2,2] row_mask:0xf bank_mask:0xf
  v_fmac_f32_dpp v31, v51, v35 quad_perm:[3,3,3,3] row_mask:0xf bank_mask:0xf
  v_add_f32 v28, v28, v29
  v_add_f32 v30, v30, v31
  v_add_f32 v28, v28, v30
  v_cvt_pk_bf16_f32 v28, 0, v28
  v_mul_f32 v28, s7, v28
  v_cvt_pk_bf16_f32 v59, 0, v28
  s_waitcnt vmcnt(3)
  s_cbranch_vccz RW_8
  s_waitcnt vmcnt(2)
RW_8:
  buffer_load_dwordx4 v[84:87], v1, s[8:11], s5 offen offset:3072 nt
  v_mfma_f32_16x16x32_bf16 v[36:39], v[136:139], v[52:55], 0
  v_mfma_f32_16x16x32_bf16 v[40:43], v[140:143], v[52:55], 0
  v_mfma_f32_16x16x32_bf16 v[44:47], v[144:147], v[52:55], 0
  v_mfma_f32_16x16x32_bf16 v[48:51], v[148:151], v[52:55], 0
  s_nop 4
  v_mul_f32_dpp v28, v36, v32 quad_perm:[0,0,0,0] row_mask:0xf bank_mask:0xf
  v_mul_f32_dpp v29, v37, v32 quad_perm:[1,1,1,1] row_mask:0xf bank_mask:0xf
  v_mul_f32_dpp v30, v38, v32 quad_perm:[2,2,2,2] row_mask:0xf bank_mask:0xf
  v_mul_f32_dpp v31, v39, v32 quad_perm:[3,3,3,3] row_mask:0xf bank_mask:0xf
  v_fmac_f32_dpp v28, v40, v33 quad_perm:[0,0,0,0] row_mask:0xf bank_mask:0xf
  v_fmac_f32_dpp v29, v41, v33 quad_perm:[1,1,1,1] row_mask:0xf bank_mask:0xf
  v_fmac_f32_dpp v30, v42, v33 quad_perm:[2,2,2,2] row_mask:0xf bank_mask:0xf
  v_fmac_f32_dpp v31, v43, v33 quad_perm:[3,3,3,3] row_mask:0xf bank_mask:0xf
  v_fmac_f32_dpp v28, v44, v34 quad_perm:[0,0,0,0] row_mask:0xf bank_mask:0xf
  v_fmac_f32_dpp v29, v45, v34 quad_perm:[1,1,1,1] row_mask:0xf bank_mask:0xf
  v_fmac_f32_dpp v30, v46, v34 quad_perm:[2,2,2,2] row_mask:0xf bank_mask:0xf
  v_fmac_f32_dpp v31, v47, v34 quad_perm:[3,3,3,3] row_mask:0xf bank_mask:0xf
  v_fmac_f32_dpp v28, v48, v35 quad_perm:[0,0,0,0] row_mask:0xf bank_mask:0xf
  v_fmac_f32_dpp v29, v49, v35 quad_perm:[1,1,1,1] row_mask:0xf bank_mask:0xf
  v_fmac_f32_dpp v30, v50, v35 quad_perm:[2,2,2,2] row_mask:0xf bank_mask:0xf
  v_fmac_f32_dpp v31, v51, v35 quad_perm:[3,3,3,3] row_mask:0xf bank_mask:0xf
  v_add_f32 v28, v28, v29
  v_add_f32 v30, v30, v31
  v_add_f32 v28, v28, v30
  v_cvt_pk_bf16_f32 v28, 0, v28
  v_mul_f32 v28, s7, v28
  v_cvt_pk_bf16_f32 v60, 0, v28
  s_waitcnt vmcnt(3)
  s_cbranch_vccz RW_9
  s_waitcnt vmcnt(2)
RW_9:
  s_add_u32 s5, s4, 327680
  buffer_load_dwordx4 v[88:91], v1, s[8:11], s5 offen offset:0 nt
  v_mfma_f32_16x16x32_bf16 v[36:39], v[152:155], v[52:55], 0
  v_mfma_f32_16x16x32_bf16 v[40:43], v[156:159], v[52:55], 0
  v_mfma_f32_16x16x32_bf16 v[44:47], v[160:163], v[52:55], 0
  v_mfma_f32_16x16x32_bf16 v[48:51], v[164:167], v[52:55], 0
  s_nop 4
  v_mul_f32_dpp v28, v36, v32 quad_perm:[0,0,0,0] row_mask:0xf bank_mask:0xf
  v_mul_f32_dpp v29, v37, v32 quad_perm:[1,1,1,1] row_mask:0xf bank_mask:0xf
  v_mul_f32_dpp v30, v38, v32 quad_perm:[2,2,2,2] row_mask:0xf bank_mask:0xf
  v_mul_f32_dpp v31, v39, v32 quad_perm:[3,3,3,3] row_mask:0xf bank_mask:0xf
  v_fmac_f32_dpp v28, v40, v33 quad_perm:[0,0,0,0] row_mask:0xf bank_mask:0xf
  v_fmac_f32_dpp v29, v41, v33 quad_perm:[1,1,1,1] row_mask:0xf bank_mask:0xf
  v_fmac_f32_dpp v30, v42, v33 quad_perm:[2,2,2,2] row_mask:0xf bank_mask:0xf
  v_fmac_f32_dpp v31, v43, v33 quad_perm:[3,3,3,3] row_mask:0xf bank_mask:0xf
  v_fmac_f32_dpp v28, v44, v34 quad_perm:[0,0,0,0] row_mask:0xf bank_mask:0xf
  v_fmac_f32_dpp v29, v45, v34 quad_perm:[1,1,1,1] row_mask:0xf bank_mask:0xf
  v_fmac_f32_dpp v30, v46, v34 quad_perm:[2,2,2,2] row_mask:0xf bank_mask:0xf
  v_fmac_f32_dpp v31, v47, v34 quad_perm:[3,3,3,3] row_mask:0xf bank_mask:0xf
  v_fmac_f32_dpp v28, v48, v35 quad_perm:[0,0,0,0] row_mask:0xf bank_mask:0xf
  v_fmac_f32_dpp v29, v49, v35 quad_perm:[1,1,1,1] row_mask:0xf bank_mask:0xf
  v_fmac_f32_dpp v30, v50, v35 quad_perm:[2,2,2,2] row_mask:0xf bank_mask:0xf
  v_fmac_f32_dpp v31, v51, v35 quad_perm:[3,3,3,3] row_mask:0xf bank_mask:0xf
  v_add_f32 v28, v28, v29
  v_add_f32 v30, v30, v31
  v_add_f32 v28, v28, v30
  v_cvt_pk_bf16_f32 v28, 0, v28
  v_mul_f32 v28, s7, v28
  v_cvt_pk_bf16_f32 v61, 0, v28
  s_waitcnt vmcnt(3)
  s_cbranch_vccz RW_10
  s_waitcnt vmcnt(2)
RW_10:
  buffer_load_dwordx4 v[92:95], v1, s[8:11], s5 offen offset:1024 nt
  ds_read_b128 v[64:67], v18 offset:29184
  ds_read_b128 v[68:71], v18 offset:30208
  s_waitcnt lgkmcnt(1)
  v_mfma_f32_16x16x32_bf16 v[36:39], v[64:67], v[52:55], 0
  s_waitcnt lgkmcnt(0)
  v_mfma_f32_16x16x32_bf16 v[40:43], v[68:71], v[52:55], 0
  ds_read_b128 v[64:67], v18 offset:31232
  ds_read_b128 v[68:71], v18 offset:32256
  s_waitcnt lgkmcnt(1)
  v_mfma_f32_16x16x32_bf16 v[44:47], v[64:67], v[52:55], 0
  s_waitcnt lgkmcnt(0)
  v_mfma_f32_16x16x32_bf16 v[48:51], v[68:71], v[52:55], 0
  v_mul_f32_dpp v28, v36, v32 quad_perm:[0,0,0,0] row_mask:0xf bank_mask:0xf
  v_mul_f32_dpp v29, v37, v32 quad_perm:[1,1,1,1] row_mask:0xf bank_mask:0xf
  v_mul_f32_dpp v30, v38, v32 quad_perm:[2,2,2,2] row_mask:0xf bank_mask:0xf
  v_mul_f32_dpp v31, v39, v32 quad_perm:[3,3,3,3] row_mask:0xf bank_mask:0xf
  v_fmac_f32_dpp v28, v40, v33 quad_perm:[0,0,0,0] row_mask:0xf bank_mask:0xf
  v_fmac_f32_dpp v29, v41, v33 quad_perm:[1,1,1,1] row_mask:0xf bank_mask:0xf
  v_fmac_f32_dpp v30, v42, v33 quad_perm:[2,2,2,2] row_mask:0xf bank_mask:0xf
  v_fmac_f32_dpp v31, v43, v33 quad_perm:[3,3,3,3] row_mask:0xf bank_mask:0xf
  v_fmac_f32_dpp v28, v44, v34 quad_perm:[0,0,0,0] row_mask:0xf bank_mask:0xf
  v_fmac_f32_dpp v29, v45, v34 quad_perm:[1,1,1,1] row_mask:0xf bank_mask:0xf
  v_fmac_f32_dpp v30, v46, v34 quad_perm:[2,2,2,2] row_mask:0xf bank_mask:0xf
  v_fmac_f32_dpp v31, v47, v34 quad_perm:[3,3,3,3] row_mask:0xf bank_mask:0xf
  v_fmac_f32_dpp v28, v48, v35 quad_perm:[0,0,0,0] row_mask:0xf bank_mask:0xf
  v_fmac_f32_dpp v29, v49, v35 quad_perm:[1,1,1,1] row_mask:0xf bank_mask:0xf
  v_fmac_f32_dpp v30, v50, v35 quad_perm:[2,2,2,2] row_mask:0xf bank_mask:0xf
  v_fmac_f32_dpp v31, v51, v35 quad_perm:[3,3,3,3] row_mask:0xf bank_mask:0xf
  v_add_f32 v28, v28, v29
  v_add_f32 v30, v30, v31
  v_add_f32 v28, v28, v30
  v_cvt_pk_bf16_f32 v28, 0, v28
  v_mul_f32 v28, s7, v28
  v_cvt_pk_bf16_f32 v62, 0, v28
  s_waitcnt vmcnt(3)
  s_cbranch_vccz RW_11
  s_waitcnt vmcnt(2)
RW_11:
  buffer_load_dwordx4 v[96:99], v1, s[8:11], s5 offen offset:2048 nt
  ds_read_b128 v[64:67], v18 offset:33280
  ds_read_b128 v[68:71], v18 offset:34304
  s_waitcnt lgkmcnt(1)
  v_mfma_f32_16x16x32_bf16 v[36:39], v[64:67], v[52:55], 0
  s_waitcnt lgkmcnt(0)
  v_mfma_f32_16x16x32_bf16 v[40:43], v[68:71], v[52:55], 0
  ds_read_b128 v[64:67], v18 offset:35328
  ds_read_b128 v[68:71], v18 offset:36352
  s_waitcnt lgkmcnt(1)
  v_mfma_f32_16x16x32_bf16 v[44:47], v[64:67], v[52:55], 0
  s_waitcnt lgkmcnt(0)
  v_mfma_f32_16x16x32_bf16 v[48:51], v[68:71], v[52:55], 0
  v_mul_f32_dpp v28, v36, v32 quad_perm:[0,0,0,0] row_mask:0xf bank_mask:0xf
  v_mul_f32_dpp v29, v37, v32 quad_perm:[1,1,1,1] row_mask:0xf bank_mask:0xf
  v_mul_f32_dpp v30, v38, v32 quad_perm:[2,2,2,2] row_mask:0xf bank_mask:0xf
  v_mul_f32_dpp v31, v39, v32 quad_perm:[3,3,3,3] row_mask:0xf bank_mask:0xf
  v_fmac_f32_dpp v28, v40, v33 quad_perm:[0,0,0,0] row_mask:0xf bank_mask:0xf
  v_fmac_f32_dpp v29, v41, v33 quad_perm:[1,1,1,1] row_mask:0xf bank_mask:0xf
  v_fmac_f32_dpp v30, v42, v33 quad_perm:[2,2,2,2] row_mask:0xf bank_mask:0xf
  v_fmac_f32_dpp v31, v43, v33 quad_perm:[3,3,3,3] row_mask:0xf bank_mask:0xf
  v_fmac_f32_dpp v28, v44, v34 quad_perm:[0,0,0,0] row_mask:0xf bank_mask:0xf
  v_fmac_f32_dpp v29, v45, v34 quad_perm:[1,1,1,1] row_mask:0xf bank_mask:0xf
  v_fmac_f32_dpp v30, v46, v34 quad_perm:[2,2,2,2] row_mask:0xf bank_mask:0xf
  v_fmac_f32_dpp v31, v47, v34 quad_perm:[3,3,3,3] row_mask:0xf bank_mask:0xf
  v_fmac_f32_dpp v28, v48, v35 quad_perm:[0,0,0,0] row_mask:0xf bank_mask:0xf
  v_fmac_f32_dpp v29, v49, v35 quad_perm:[1,1,1,1] row_mask:0xf bank_mask:0xf
  v_fmac_f32_dpp v30, v50, v35 quad_perm:[2,2,2,2] row_mask:0xf bank_mask:0xf
  v_fmac_f32_dpp v31, v51, v35 quad_perm:[3,3,3,3] row_mask:0xf bank_mask:0xf
  v_add_f32 v28, v28, v29
  v_add_f32 v30, v30, v31
  v_add_f32 v28, v28, v30
  v_cvt_pk_bf16_f32 v28, 0, v28
  v_mul_f32 v28, s7, v28
  v_cvt_pk_bf16_f32 v63, 0, v28
  s_waitcnt vmcnt(3)
  s_cbranch_vccz RW_12
  s_waitcnt vmcnt(2)
RW_12:
  buffer_load_dwordx4 v[100:103], v1, s[8:11], s5 offen offset:3072 nt
  ds_read_b128 v[64:67], v18 offset:37376
  ds_read_b128 v[68:71], v18 offset:38400
  s_waitcnt lgkmcnt(1)
  v_mfma_f32_16x16x32_bf16 v[36:39], v[64:67], v[52:55], 0
  s_waitcnt lgkmcnt(0)
  v_mfma_f32_16x16x32_bf16 v[40:43], v[68:71], v[52:55], 0
  ds_read_b128 v[64:67], v18 offset:39424
  ds_read_b128 v[68:71], v18 offset:40448
  s_waitcnt lgkmcnt(1)
  v_mfma_f32_16x16x32_bf16 v[44:47], v[64:67], v[52:55], 0
  s_waitcnt lgkmcnt(0)
  v_mfma_f32_16x16x32_bf16 v[48:51], v[68:71], v[52:55], 0
  v_mul_f32_dpp v28, v36, v32 quad_perm:[0,0,0,0] row_mask:0xf bank_mask:0xf
  v_mul_f32_dpp v29, v37, v32 quad_perm:[1,1,1,1] row_mask:0xf bank_mask:0xf
  v_mul_f32_dpp v30, v38, v32 quad_perm:[2,2,2,2] row_mask:0xf bank_mask:0xf
  v_mul_f32_dpp v31, v39, v32 quad_perm:[3,3,3,3] row_mask:0xf bank_mask:0xf
  v_fmac_f32_dpp v28, v40, v33 quad_perm:[0,0,0,0] row_mask:0xf bank_mask:0xf
  v_fmac_f32_dpp v29, v41, v33 quad_perm:[1,1,1,1] row_mask:0xf bank_mask:0xf
  v_fmac_f32_dpp v30, v42, v33 quad_perm:[2,2,2,2] row_mask:0xf bank_mask:0xf
  v_fmac_f32_dpp v31, v43, v33 quad_perm:[3,3,3,3] row_mask:0xf bank_mask:0xf
  v_fmac_f32_dpp v28, v44, v34 quad_perm:[0,0,0,0] row_mask:0xf bank_mask:0xf
  v_fmac_f32_dpp v29, v45, v34 quad_perm:[1,1,1,1] row_mask:0xf bank_mask:0xf
  v_fmac_f32_dpp v30, v46, v34 quad_perm:[2,2,2,2] row_mask:0xf bank_mask:0xf
  v_fmac_f32_dpp v31, v47, v34 quad_perm:[3,3,3,3] row_mask:0xf bank_mask:0xf
  v_fmac_f32_dpp v28, v48, v35 quad_perm:[0,0,0,0] row_mask:0xf bank_mask:0xf
  v_fmac_f32_dpp v29, v49, v35 quad_perm:[1,1,1,1] row_mask:0xf bank_mask:0xf
  v_fmac_f32_dpp v30, v50, v35 quad_perm:[2,2,2,2] row_mask:0xf bank_mask:0xf
  v_fmac_f32_dpp v31, v51, v35 quad_perm:[3,3,3,3] row_mask:0xf bank_mask:0xf
  v_add_f32 v28, v28, v29
  v_add_f32 v30, v30, v31
  v_add_f32 v28, v28, v30
  v_cvt_pk_bf16_f32 v28, 0, v28
  v_mul_f32 v28, s7, v28
  v_cvt_pk_bf16_f32 v64, 0, v28
  s_waitcnt vmcnt(3)
  s_cbranch_vccz RW_13
  s_waitcnt vmcnt(2)
RW_13:
  s_add_u32 s5, s4, 360448
  buffer_load_dwordx4 v[104:107], v1, s[8:11], s5 offen offset:0 nt
  v_mfma_f32_16x16x32_bf16 v[36:39], v[72:75], v[52:55], 0
  v_mfma_f32_16x16x32_bf16 v[40:43], v[76:79], v[52:55], 0
  v_mfma_f32_16x16x32_bf16 v[44:47], v[80:83], v[52:55], 0
  v_mfma_f32_16x16x32_bf16 v[48:51], v[84:87], v[52:55], 0
  s_nop 4
  v_mul_f32_dpp v28, v36, v32 quad_perm:[0,0,0,0] row_mask:0xf bank_mask:0xf
  v_mul_f32_dpp v29, v37, v32 quad_perm:[1,1,1,1] row_mask:0xf bank_mask:0xf
  v_mul_f32_dpp v30, v38, v32 quad_perm:[2,2,2,2] row_mask:0xf bank_mask:0xf
  v_mul_f32_dpp v31, v39, v32 quad_perm:[3,3,3,3] row_mask:0xf bank_mask:0xf
  v_fmac_f32_dpp v28, v40, v33 quad_perm:[0,0,0,0] row_mask:0xf bank_mask:0xf
  v_fmac_f32_dpp v29, v41, v33 quad_perm:[1,1,1,1] row_mask:0xf bank_mask:0xf
  v_fmac_f32_dpp v30, v42, v33 quad_perm:[2,2,2,2] row_mask:0xf bank_mask:0xf
  v_fmac_f32_dpp v31, v43, v33 quad_perm:[3,3,3,3] row_mask:0xf bank_mask:0xf
  v_fmac_f32_dpp v28, v44, v34 quad_perm:[0,0,0,0] row_mask:0xf bank_mask:0xf
  v_fmac_f32_dpp v29, v45, v34 quad_perm:[1,1,1,1] row_mask:0xf bank_mask:0xf
  v_fmac_f32_dpp v30, v46, v34 quad_perm:[2,2,2,2] row_mask:0xf bank_mask:0xf
  v_fmac_f32_dpp v31, v47, v34 quad_perm:[3,3,3,3] row_mask:0xf bank_mask:0xf
  v_fmac_f32_dpp v28, v48, v35 quad_perm:[0,0,0,0] row_mask:0xf bank_mask:0xf
  v_fmac_f32_dpp v29, v49, v35 quad_perm:[1,1,1,1] row_mask:0xf bank_mask:0xf
  v_fmac_f32_dpp v30, v50, v35 quad_perm:[2,2,2,2] row_mask:0xf bank_mask:0xf
  v_fmac_f32_dpp v31, v51, v35 quad_perm:[3,3,3,3] row_mask:0xf bank_mask:0xf
  v_add_f32 v28, v28, v29
  v_add_f32 v30, v30, v31
  v_add_f32 v28, v28, v30
  v_cvt_pk_bf16_f32 v28, 0, v28
  v_mul_f32 v28, s7, v28
  v_cvt_pk_bf16_f32 v65, 0, v28
  s_waitcnt vmcnt(3)
  s_cbranch_vccz RW_14
  s_waitcnt vmcnt(2)
RW_14:
  buffer_load_dwordx4 v[108:111], v1, s[8:11], s5 offen offset:1024 nt
  s_waitcnt vmcnt(3)
  s_cbranch_vccz RW_15
  s_waitcnt vmcnt(2)
RW_15:
  buffer_load_dwordx4 v[112:115], v1, s[8:11], s5 offen offset:2048 nt
  s_waitcnt vmcnt(3)
  s_cbranch_vccz RW_16
  s_waitcnt vmcnt(2)
RW_16:
  buffer_load_dwordx4 v[116:119], v1, s[8:11], s5 offen offset:3072 nt
  v_mfma_f32_16x16x32_bf16 v[36:39], v[88:91], v[52:55], 0
  v_mfma_f32_16x16x32_bf16 v[40:43], v[92:95], v[52:55], 0
  v_mfma_f32_16x16x32_bf16 v[44:47], v[96:99], v[52:55], 0
  v_mfma_f32_16x16x32_bf16 v[48:51], v[100:103], v[52:55], 0
  s_nop 4
  v_mul_f32_dpp v28, v36, v32 quad_perm:[0,0,0,0] row_mask:0xf bank_mask:0xf
  v_mul_f32_dpp v29, v37, v32 quad_perm:[1,1,1,1] row_mask:0xf bank_mask:0xf
  v_mul_f32_dpp v30, v38, v32 quad_perm:[2,2,2,2] row_mask:0xf bank_mask:0xf
  v_mul_f32_dpp v31, v39, v32 quad_perm:[3,3,3,3] row_mask:0xf bank_mask:0xf
  v_fmac_f32_dpp v28, v40, v33 quad_perm:[0,0,0,0] row_mask:0xf bank_mask:0xf
  v_fmac_f32_dpp v29, v41, v33 quad_perm:[1,1,1,1] row_mask:0xf bank_mask:0xf
  v_fmac_f32_dpp v30, v42, v33 quad_perm:[2,2,2,2] row_mask:0xf bank_mask:0xf
  v_fmac_f32_dpp v31, v43, v33 quad_perm:[3,3,3,3] row_mask:0xf bank_mask:0xf
  v_fmac_f32_dpp v28, v44, v34 quad_perm:[0,0,0,0] row_mask:0xf bank_mask:0xf
  v_fmac_f32_dpp v29, v45, v34 quad_perm:[1,1,1,1] row_mask:0xf bank_mask:0xf
  v_fmac_f32_dpp v30, v46, v34 quad_perm:[2,2,2,2] row_mask:0xf bank_mask:0xf
  v_fmac_f32_dpp v31, v47, v34 quad_perm:[3,3,3,3] row_mask:0xf bank_mask:0xf
  v_fmac_f32_dpp v28, v48, v35 quad_perm:[0,0,0,0] row_mask:0xf bank_mask:0xf
  v_fmac_f32_dpp v29, v49, v35 quad_perm:[1,1,1,1] row_mask:0xf bank_mask:0xf
  v_fmac_f32_dpp v30, v50, v35 quad_perm:[2,2,2,2] row_mask:0xf bank_mask:0xf
  v_fmac_f32_dpp v31, v51, v35 quad_perm:[3,3,3,3] row_mask:0xf bank_mask:0xf
  v_add_f32 v28, v28, v29
  v_add_f32 v30, v30, v31
  v_add_f32 v28, v28, v30
  v_cvt_pk_bf16_f32 v28, 0, v28
  v_mul_f32 v28, s7, v28
  v_cvt_pk_bf16_f32 v66, 0, v28
  s_waitcnt vmcnt(3)
  s_cbranch_vccz RW_17
  s_waitcnt vmcnt(2)
RW_17:
  s_add_u32 s5, s4, 393216
  buffer_load_dwordx4 v[120:123], v1, s[8:11], s5 offen offset:0 nt
  s_waitcnt vmcnt(3)
  s_cbranch_vccz RW_18
  s_waitcnt vmcnt(2)
RW_18:
  buffer_load_dwordx4 v[124:127], v1, s[8:11], s5 offen offset:1024 nt
  s_waitcnt vmcnt(3)
  s_cbranch_vccz RW_19
  s_waitcnt vmcnt(2)
RW_19:
  buffer_load_dwordx4 v[128:131], v1, s[8:11], s5 offen offset:2048 nt
  s_waitcnt vmcnt(3)
  s_cbranch_vccz RW_20
  s_waitcnt vmcnt(2)
RW_20:
  buffer_load_dwordx4 v[132:135], v1, s[8:11], s5 offen offset:3072 nt
  v_mfma_f32_16x16x32_bf16 v[36:39], v[104:107], v[52:55], 0
  v_mfma_f32_16x16x32_bf16 v[40:43], v[108:111], v[52:55], 0
  v_mfma_f32_16x16x32_bf16 v[44:47], v[112:115], v[52:55], 0
  v_mfma_f32_16x16x32_bf16 v[48:51], v[116:119], v[52:55], 0
  s_nop 4
  v_mul_f32_dpp v28, v36, v32 quad_perm:[0,0,0,0] row_mask:0xf bank_mask:0xf
  v_mul_f32_dpp v29, v37, v32 quad_perm:[1,1,1,1] row_mask:0xf bank_mask:0xf
  v_mul_f32_dpp v30, v38, v32 quad_perm:[2,2,2,2] row_mask:0xf bank_mask:0xf
  v_mul_f32_dpp v31, v39, v32 quad_perm:[3,3,3,3] row_mask:0xf bank_mask:0xf
  v_fmac_f32_dpp v28, v40, v33 quad_perm:[0,0,0,0] row_mask:0xf bank_mask:0xf
  v_fmac_f32_dpp v29, v41, v33 quad_perm:[1,1,1,1] row_mask:0xf bank_mask:0xf
  v_fmac_f32_dpp v30, v42, v33 quad_perm:[2,2,2,2] row_mask:0xf bank_mask:0xf
  v_fmac_f32_dpp v31, v43, v33 quad_perm:[3,3,3,3] row_mask:0xf bank_mask:0xf
  v_fmac_f32_dpp v28, v44, v34 quad_perm:[0,0,0,0] row_mask:0xf bank_mask:0xf
  v_fmac_f32_dpp v29, v45, v34 quad_perm:[1,1,1,1] row_mask:0xf bank_mask:0xf
  v_fmac_f32_dpp v30, v46, v34 quad_perm:[2,2,2,2] row_mask:0xf bank_mask:0xf
  v_fmac_f32_dpp v31, v47, v34 quad_perm:[3,3,3,3] row_mask:0xf bank_mask:0xf
  v_fmac_f32_dpp v28, v48, v35 quad_perm:[0,0,0,0] row_mask:0xf bank_mask:0xf
  v_fmac_f32_dpp v29, v49, v35 quad_perm:[1,1,1,1] row_mask:0xf bank_mask:0xf
  v_fmac_f32_dpp v30, v50, v35 quad_perm:[2,2,2,2] row_mask:0xf bank_mask:0xf
  v_fmac_f32_dpp v31, v51, v35 quad_perm:[3,3,3,3] row_mask:0xf bank_mask:0xf
  v_add_f32 v28, v28, v29
  v_add_f32 v30, v30, v31
  v_add_f32 v28, v28, v30
  v_cvt_pk_bf16_f32 v28, 0, v28
  v_mul_f32 v28, s7, v28
  v_cvt_pk_bf16_f32 v67, 0, v28
  s_waitcnt vmcnt(3)
  s_cbranch_vccz RW_21
  s_waitcnt vmcnt(2)
RW_21:
  s_add_u32 s5, s4, 425984
  buffer_load_dwordx4 v[136:139], v1, s[8:11], s5 offen offset:0 nt
  s_waitcnt vmcnt(3)
  s_cbranch_vccz RW_22
  s_waitcnt vmcnt(2)
RW_22:
  buffer_load_dwordx4 v[140:143], v1, s[8:11], s5 offen offset:1024 nt
  s_waitcnt vmcnt(3)
  s_cbranch_vccz RW_23
  s_waitcnt vmcnt(2)
RW_23:
  buffer_load_dwordx4 v[144:147], v1, s[8:11], s5 offen offset:2048 nt
  s_waitcnt vmcnt(3)
  s_cbranch_vccz RW_24
  s_waitcnt vmcnt(2)
RW_24:
  buffer_load_dwordx4 v[148:151], v1, s[8:11], s5 offen offset:3072 nt
  v_mfma_f32_16x16x32_bf16 v[36:39], v[120:123], v[52:55], 0
  v_mfma_f32_16x16x32_bf16 v[40:43], v[124:127], v[52:55], 0
  v_mfma_f32_16x16x32_bf16 v[44:47], v[128:131], v[52:55], 0
  v_mfma_f32_16x16x32_bf16 v[48:51], v[132:135], v[52:55], 0
  s_nop 4
  v_mul_f32_dpp v28, v36, v32 quad_perm:[0,0,0,0] row_mask:0xf bank_mask:0xf
  v_mul_f32_dpp v29, v37, v32 quad_perm:[1,1,1,1] row_mask:0xf bank_mask:0xf
  v_mul_f32_dpp v30, v38, v32 quad_perm:[2,2,2,2] row_mask:0xf bank_mask:0xf
  v_mul_f32_dpp v31, v39, v32 quad_perm:[3,3,3,3] row_mask:0xf bank_mask:0xf
  v_fmac_f32_dpp v28, v40, v33 quad_perm:[0,0,0,0] row_mask:0xf bank_mask:0xf
  v_fmac_f32_dpp v29, v41, v33 quad_perm:[1,1,1,1] row_mask:0xf bank_mask:0xf
  v_fmac_f32_dpp v30, v42, v33 quad_perm:[2,2,2,2] row_mask:0xf bank_mask:0xf
  v_fmac_f32_dpp v31, v43, v33 quad_perm:[3,3,3,3] row_mask:0xf bank_mask:0xf
  v_fmac_f32_dpp v28, v44, v34 quad_perm:[0,0,0,0] row_mask:0xf bank_mask:0xf
  v_fmac_f32_dpp v29, v45, v34 quad_perm:[1,1,1,1] row_mask:0xf bank_mask:0xf
  v_fmac_f32_dpp v30, v46, v34 quad_perm:[2,2,2,2] row_mask:0xf bank_mask:0xf
  v_fmac_f32_dpp v31, v47, v34 quad_perm:[3,3,3,3] row_mask:0xf bank_mask:0xf
  v_fmac_f32_dpp v28, v48, v35 quad_perm:[0,0,0,0] row_mask:0xf bank_mask:0xf
  v_fmac_f32_dpp v29, v49, v35 quad_perm:[1,1,1,1] row_mask:0xf bank_mask:0xf
  v_fmac_f32_dpp v30, v50, v35 quad_perm:[2,2,2,2] row_mask:0xf bank_mask:0xf
  v_fmac_f32_dpp v31, v51, v35 quad_perm:[3,3,3,3] row_mask:0xf bank_mask:0xf
  v_add_f32 v28, v28, v29
  v_add_f32 v30, v30, v31
  v_add_f32 v28, v28, v30
  v_cvt_pk_bf16_f32 v28, 0, v28
  v_mul_f32 v28, s7, v28
  v_cvt_pk_bf16_f32 v68, 0, v28
  s_waitcnt vmcnt(3)
  s_cbranch_vccz RW_25
  s_waitcnt vmcnt(2)
RW_25:
  s_add_u32 s5, s4, 458752
  buffer_load_dwordx4 v[152:155], v1, s[8:11], s5 offen offset:0 nt
  s_waitcnt vmcnt(3)
  s_cbranch_vccz RW_26
  s_waitcnt vmcnt(2)
RW_26:
  buffer_load_dwordx4 v[156:159], v1, s[8:11], s5 offen offset:1024 nt
  s_waitcnt vmcnt(3)
  s_cbranch_vccz RW_27
  s_waitcnt vmcnt(2)
RW_27:
  buffer_load_dwordx4 v[160:163], v1, s[8:11], s5 offen offset:2048 nt
  s_waitcnt vmcnt(3)
  s_cbranch_vccz RW_28
  s_waitcnt vmcnt(2)
RW_28:
  buffer_load_dwordx4 v[164:167], v1, s[8:11], s5 offen offset:3072 nt
  v_mfma_f32_16x16x32_bf16 v[36:39], v[136:139], v[52:55], 0
  v_mfma_f32_16x16x32_bf16 v[40:43], v[140:143], v[52:55], 0
  v_mfma_f32_16x16x32_bf16 v[44:47], v[144:147], v[52:55], 0
  v_mfma_f32_16x16x32_bf16 v[48:51], v[148:151], v[52:55], 0
  s_nop 4
  v_mul_f32_dpp v28, v36, v32 quad_perm:[0,0,0,0] row_mask:0xf bank_mask:0xf
  v_mul_f32_dpp v29, v37, v32 quad_perm:[1,1,1,1] row_mask:0xf bank_mask:0xf
  v_mul_f32_dpp v30, v38, v32 quad_perm:[2,2,2,2] row_mask:0xf bank_mask:0xf
  v_mul_f32_dpp v31, v39, v32 quad_perm:[3,3,3,3] row_mask:0xf bank_mask:0xf
  v_fmac_f32_dpp v28, v40, v33 quad_perm:[0,0,0,0] row_mask:0xf bank_mask:0xf
  v_fmac_f32_dpp v29, v41, v33 quad_perm:[1,1,1,1] row_mask:0xf bank_mask:0xf
  v_fmac_f32_dpp v30, v42, v33 quad_perm:[2,2,2,2] row_mask:0xf bank_mask:0xf
  v_fmac_f32_dpp v31, v43, v33 quad_perm:[3,3,3,3] row_mask:0xf bank_mask:0xf
  v_fmac_f32_dpp v28, v44, v34 quad_perm:[0,0,0,0] row_mask:0xf bank_mask:0xf
  v_fmac_f32_dpp v29, v45, v34 quad_perm:[1,1,1,1] row_mask:0xf bank_mask:0xf
  v_fmac_f32_dpp v30, v46, v34 quad_perm:[2,2,2,2] row_mask:0xf bank_mask:0xf
  v_fmac_f32_dpp v31, v47, v34 quad_perm:[3,3,3,3] row_mask:0xf bank_mask:0xf
  v_fmac_f32_dpp v28, v48, v35 quad_perm:[0,0,0,0] row_mask:0xf bank_mask:0xf
  v_fmac_f32_dpp v29, v49, v35 quad_perm:[1,1,1,1] row_mask:0xf bank_mask:0xf
  v_fmac_f32_dpp v30, v50, v35 quad_perm:[2,2,2,2] row_mask:0xf bank_mask:0xf
  v_fmac_f32_dpp v31, v51, v35 quad_perm:[3,3,3,3] row_mask:0xf bank_mask:0xf
  v_add_f32 v28, v28, v29
  v_add_f32 v30, v30, v31
  v_add_f32 v28, v28, v30
  v_cvt_pk_bf16_f32 v28, 0, v28
  v_mul_f32 v28, s7, v28
  v_cvt_pk_bf16_f32 v69, 0, v28
  s_waitcnt vmcnt(3)
  s_cbranch_vccz RW_29
  s_waitcnt vmcnt(2)
RW_29:
  s_add_u32 s5, s4, 491520
  buffer_load_dwordx4 v[72:75], v1, s[8:11], s5 offen offset:0 nt
  s_waitcnt vmcnt(3)
  s_cbranch_vccz RW_30
  s_waitcnt vmcnt(2)
RW_30:
  buffer_load_dwordx4 v[76:79], v1, s[8:11], s5 offen offset:1024 nt
  s_waitcnt vmcnt(3)
  s_cbranch_vccz RW_31
  s_waitcnt vmcnt(2)
RW_31:
  buffer_load_dwordx4 v[80:83], v1, s[8:11], s5 offen offset:2048 nt
  s_waitcnt vmcnt(3)
  s_cbranch_vccz RW_32
  s_waitcnt vmcnt(2)
RW_32:
  buffer_load_dwordx4 v[84:87], v1, s[8:11], s5 offen offset:3072 nt
  v_mfma_f32_16x16x32_bf16 v[36:39], v[152:155], v[52:55], 0
  v_mfma_f32_16x16x32_bf16 v[40:43], v[156:159], v[52:55], 0
  v_mfma_f32_16x16x32_bf16 v[44:47], v[160:163], v[52:55], 0
  v_mfma_f32_16x16x32_bf16 v[48:51], v[164:167], v[52:55], 0
  s_nop 4
  v_mul_f32_dpp v28, v36, v32 quad_perm:[0,0,0,0] row_mask:0xf bank_mask:0xf
  v_mul_f32_dpp v29, v37, v32 quad_perm:[1,1,1,1] row_mask:0xf bank_mask:0xf
  v_mul_f32_dpp v30, v38, v32 quad_perm:[2,2,2,2] row_mask:0xf bank_mask:0xf
  v_mul_f32_dpp v31, v39, v32 quad_perm:[3,3,3,3] row_mask:0xf bank_mask:0xf
  v_fmac_f32_dpp v28, v40, v33 quad_perm:[0,0,0,0] row_mask:0xf bank_mask:0xf
  v_fmac_f32_dpp v29, v41, v33 quad_perm:[1,1,1,1] row_mask:0xf bank_mask:0xf
  v_fmac_f32_dpp v30, v42, v33 quad_perm:[2,2,2,2] row_mask:0xf bank_mask:0xf
  v_fmac_f32_dpp v31, v43, v33 quad_perm:[3,3,3,3] row_mask:0xf bank_mask:0xf
  v_fmac_f32_dpp v28, v44, v34 quad_perm:[0,0,0,0] row_mask:0xf bank_mask:0xf
  v_fmac_f32_dpp v29, v45, v34 quad_perm:[1,1,1,1] row_mask:0xf bank_mask:0xf
  v_fmac_f32_dpp v30, v46, v34 quad_perm:[2,2,2,2] row_mask:0xf bank_mask:0xf
  v_fmac_f32_dpp v31, v47, v34 quad_perm:[3,3,3,3] row_mask:0xf bank_mask:0xf
  v_fmac_f32_dpp v28, v48, v35 quad_perm:[0,0,0,0] row_mask:0xf bank_mask:0xf
  v_fmac_f32_dpp v29, v49, v35 quad_perm:[1,1,1,1] row_mask:0xf bank_mask:0xf
  v_fmac_f32_dpp v30, v50, v35 quad_perm:[2,2,2,2] row_mask:0xf bank_mask:0xf
  v_fmac_f32_dpp v31, v51, v35 quad_perm:[3,3,3,3] row_mask:0xf bank_mask:0xf
  v_add_f32 v28, v28, v29
  v_add_f32 v30, v30, v31
  v_add_f32 v28, v28, v30
  v_cvt_pk_bf16_f32 v28, 0, v28
  v_mul_f32 v28, s7, v28
  v_cvt_pk_bf16_f32 v70, 0, v28
  s_waitcnt vmcnt(2)
  s_add_u32 s5, s4, 0
  buffer_load_dwordx4 v[88:91], v2, s[12:15], s5 offen offset:0 nt
  s_waitcnt vmcnt(2)
  buffer_load_dwordx4 v[92:95], v2, s[12:15], s5 offen offset:1024 nt
  s_waitcnt vmcnt(2)
  buffer_load_dwordx4 v[96:99], v2, s[12:15], s5 offen offset:2048 nt
  v_mfma_f32_16x16x32_bf16 v[36:39], v[72:75], v[52:55], 0
  v_mfma_f32_16x16x32_bf16 v[40:43], v[76:79], v[52:55], 0
  v_mfma_f32_16x16x32_bf16 v[44:47], v[80:83], v[52:55], 0
  v_mfma_f32_16x16x32_bf16 v[48:51], v[84:87], v[52:55], 0
  s_nop 4
  v_mul_f32_dpp v28, v36, v32 quad_perm:[0,0,0,0] row_mask:0xf bank_mask:0xf
  v_mul_f32_dpp v29, v37, v32 quad_perm:[1,1,1,1] row_mask:0xf bank_mask:0xf
  v_mul_f32_dpp v30, v38, v32 quad_perm:[2,2,2,2] row_mask:0xf bank_mask:0xf
  v_mul_f32_dpp v31, v39, v32 quad_perm:[3,3,3,3] row_mask:0xf bank_mask:0xf
  v_fmac_f32_dpp v28, v40, v33 quad_perm:[0,0,0,0] row_mask:0xf bank_mask:0xf
  v_fmac_f32_dpp v29, v41, v33 quad_perm:[1,1,1,1] row_mask:0xf bank_mask:0xf
  v_fmac_f32_dpp v30, v42, v33 quad_perm:[2,2,2,2] row_mask:0xf bank_mask:0xf
  v_fmac_f32_dpp v31, v43, v33 quad_perm:[3,3,3,3] row_mask:0xf bank_mask:0xf
  v_fmac_f32_dpp v28, v44, v34 quad_perm:[0,0,0,0] row_mask:0xf bank_mask:0xf
  v_fmac_f32_dpp v29, v45, v34 quad_perm:[1,1,1,1] row_mask:0xf bank_mask:0xf
  v_fmac_f32_dpp v30, v46, v34 quad_perm:[2,2,2,2] row_mask:0xf bank_mask:0xf
  v_fmac_f32_dpp v31, v47, v34 quad_perm:[3,3,3,3] row_mask:0xf bank_mask:0xf
  v_fmac_f32_dpp v28, v48, v35 quad_perm:[0,0,0,0] row_mask:0xf bank_mask:0xf
  v_fmac_f32_dpp v29, v49, v35 quad_perm:[1,1,1,1] row_mask:0xf bank_mask:0xf
  v_fmac_f32_dpp v30, v50, v35 quad_perm:[2,2,2,2] row_mask:0xf bank_mask:0xf
  v_fmac_f32_dpp v31, v51, v35 quad_perm:[3,3,3,3] row_mask:0xf bank_mask:0xf
  v_add_f32 v28, v28, v29
  v_add_f32 v30, v30, v31
  v_add_f32 v28, v28, v30
  v_cvt_pk_bf16_f32 v28, 0, v28
  v_mul_f32 v28, s7, v28
  v_cvt_pk_bf16_f32 v71, 0, v28
  v_max3_f32 v14, v56, v57, v58
  v_max3_f32 v15, v59, v60, v61
  v_max3_f32 v14, v14, v62, v63
  v_max3_f32 v15, v15, v64, v65
  v_max3_f32 v14, v14, v66, v67
  v_max3_f32 v15, v15, v68, v69
  v_max3_f32 v14, v14, v70, v71
  v_max_f32 v14, v14, v15
  s_nop 1
  v_max_f32_dpp v14, v14, v14 quad_perm:[1,0,3,2] row_mask:0xf bank_mask:0xf
  s_nop 1
  v_max_f32_dpp v14, v14, v14 quad_perm:[2,3,0,1] row_mask:0xf bank_mask:0xf
  v_sub_f32 v36, v56, v14
  v_sub_f32 v37, v57, v14
  v_sub_f32 v38, v58, v14
  v_sub_f32 v39, v59, v14
  v_sub_f32 v40, v60, v14
  v_sub_f32 v41, v61, v14
  v_sub_f32 v42, v62, v14
  v_sub_f32 v43, v63, v14
  v_sub_f32 v44, v64, v14
  v_sub_f32 v45, v65, v14
  v_sub_f32 v46, v66, v14
  v_sub_f32 v47, v67, v14
  v_sub_f32 v48, v68, v14
  v_sub_f32 v49, v69, v14
  v_sub_f32 v50, v70, v14
  v_sub_f32 v51, v71, v14
  v_mul_f32 v36, s6, v36
  v_mul_f32 v37, s6, v37
  v_mul_f32 v38, s6, v38
  v_mul_f32 v39, s6, v39
  v_mul_f32 v40, s6, v40
  v_mul_f32 v41, s6, v41
  v_mul_f32 v42, s6, v42
  v_mul_f32 v43, s6, v43
  v_mul_f32 v44, s6, v44
  v_mul_f32 v45, s6, v45
  v_mul_f32 v46, s6, v46
  v_mul_f32 v47, s6, v47
  v_mul_f32 v48, s6, v48
  v_mul_f32 v49, s6, v49
  v_mul_f32 v50, s6, v50
  v_mul_f32 v51, s6, v51
  v_exp_f32 v36, v36
  v_exp_f32 v37, v37
  v_exp_f32 v38, v38
  v_exp_f32 v39, v39
  v_exp_f32 v40, v40
  v_exp_f32 v41, v41
  v_exp_f32 v42, v42
  v_exp_f32 v43, v43
  v_exp_f32 v44, v44
  v_exp_f32 v45, v45
  v_exp_f32 v46, v46
  v_exp_f32 v47, v47
  v_exp_f32 v48, v48
  v_exp_f32 v49, v49
  v_exp_f32 v50, v50
  v_exp_f32 v51, v51
  v_add_f32 v36, v36, v44
  v_add_f32 v37, v37, v45
  v_add_f32 v38, v38, v46
  v_add_f32 v39, v39, v47
  v_add_f32 v40, v40, v48
  v_add_f32 v41, v41, v49
  v_add_f32 v42, v42, v50
  v_add_f32 v43, v43, v51
  v_add_f32 v36, v36, v40
  v_add_f32 v37, v37, v41
  v_add_f32 v38, v38, v42
  v_add_f32 v39, v39, v43
  v_add_f32 v36, v36, v38
  v_add_f32 v37, v37, v39
  v_add_f32 v36, v36, v37
  v_mov_b32 v15, v36
  s_nop 1
  v_add_f32_dpp v15, v15, v15 quad_perm:[1,0,3,2] row_mask:0xf bank_mask:0xf
  s_nop 1
  v_add_f32_dpp v15, v15, v15 quad_perm:[2,3,0,1] row_mask:0xf bank_mask:0xf
  s_mov_b32 exec_lo, 0x00110011
  s_mov_b32 exec_hi, 0x00110011
  ds_write_b64 v10, v[14:15] offset:1024
  s_mov_b64 exec, 1
  v_mov_b32 v16, 1
  s_waitcnt lgkmcnt(0)
  ds_add_u32 v7, v16 offset:8
  s_mov_b64 exec, -1
  s_waitcnt vmcnt(2)
  buffer_load_dwordx4 v[100:103], v2, s[12:15], s5 offen offset:3072 nt
  s_waitcnt vmcnt(2)
  s_add_u32 s5, s4, 32768
  buffer_load_dwordx4 v[104:107], v2, s[12:15], s5 offen offset:0 nt
  s_waitcnt vmcnt(2)
  buffer_load_dwordx4 v[108:111], v2, s[12:15], s5 offen offset:1024 nt
  s_waitcnt vmcnt(2)
  buffer_load_dwordx4 v[112:115], v2, s[12:15], s5 offen offset:2048 nt
  s_waitcnt vmcnt(2)
  buffer_load_dwordx4 v[116:119], v2, s[12:15], s5 offen offset:3072 nt
  s_waitcnt vmcnt(2)
  s_add_u32 s5, s4, 65536
  buffer_load_dwordx4 v[120:123], v2, s[12:15], s5 offen offset:0 nt
  s_waitcnt vmcnt(2)
  buffer_load_dwordx4 v[124:127], v2, s[12:15], s5 offen offset:1024 nt
  s_waitcnt vmcnt(2)
  buffer_load_dwordx4 v[128:131], v2, s[12:15], s5 offen offset:2048 nt
  s_waitcnt vmcnt(2)
  buffer_load_dwordx4 v[132:135], v2, s[12:15], s5 offen offset:3072 nt
  s_waitcnt vmcnt(2)
  s_add_u32 s5, s4, 98304
  buffer_load_dwordx4 v[136:139], v2, s[12:15], s5 offen offset:0 nt
  s_waitcnt vmcnt(2)
  buffer_load_dwordx4 v[140:143], v2, s[12:15], s5 offen offset:1024 nt
  s_waitcnt vmcnt(2)
  buffer_load_dwordx4 v[144:147], v2, s[12:15], s5 offen offset:2048 nt
  s_waitcnt vmcnt(2)
  buffer_load_dwordx4 v[148:151], v2, s[12:15], s5 offen offset:3072 nt
  s_waitcnt vmcnt(2)
  s_add_u32 s5, s4, 131072
  buffer_load_dwordx4 v[152:155], v2, s[12:15], s5 offen offset:0 nt
  s_waitcnt vmcnt(2)
  buffer_load_dwordx4 v[156:159], v2, s[12:15], s5 offen offset:1024 nt
  s_waitcnt vmcnt(2)
  buffer_load_dwordx4 v[160:163], v2, s[12:15], s5 offen offset:2048 nt
  s_waitcnt vmcnt(2)
  buffer_load_dwordx4 v[164:167], v2, s[12:15], s5 offen offset:3072 nt
  s_waitcnt vmcnt(2)
  s_add_u32 s5, s4, 163840
  buffer_load_dwordx4 v[72:75], v2, s[12:15], s5 offen offset:0 nt
  s_waitcnt vmcnt(2)
  buffer_load_dwordx4 v[76:79], v2, s[12:15], s5 offen offset:1024 nt
  s_waitcnt vmcnt(2)
  buffer_load_dwordx4 v[80:83], v2, s[12:15], s5 offen offset:2048 nt
  s_waitcnt vmcnt(2)
  buffer_load_dwordx4 v[84:87], v2, s[12:15], s5 offen offset:3072 nt
  s_mov_b32 s90, 40000
SP_33:
  ds_read_b32 v13, v7 offset:4
  s_waitcnt lgkmcnt(0)
  v_readfirstlane_b32 s91, v13
  s_nop 3
  s_cmp_eq_u32 s91, 1
  s_cbranch_scc1 SPO_34
  s_sleep 1
  s_sub_u32 s90, s90, 1
  s_cbranch_scc0 SP_33
  s_or_b32 s95, s95, 4
SPO_34:
  s_memrealtime s[28:29]
  ds_read_b64 v[14:15], v11 offset:64
  ds_read_b32 v13, v7 offset:52
  s_waitcnt lgkmcnt(0)
  v_readfirstlane_b32 s23, v13
  s_nop 3
  s_sub_u32 s23, s23, s28
  s_add_u32 s23, s23, 690
  s_mov_b32 s21, 0
  s_cmp_gt_i32 s23, 1
  s_cselect_b32 s21, 1, s21
  s_cmp_gt_i32 s23, 51
  s_cselect_b32 s21, 2, s21
  s_cmp_gt_i32 s23, 101
  s_cselect_b32 s21, 3, s21
  s_cmp_gt_i32 s23, 151
  s_cselect_b32 s21, 4, s21
  v_sub_f32 v56, v56, v14
  v_sub_f32 v57, v57, v14
  v_sub_f32 v58, v58, v14
  v_sub_f32 v59, v59, v14
  v_sub_f32 v60, v60, v14
  v_sub_f32 v61, v61, v14
  v_sub_f32 v62, v62, v14
  v_sub_f32 v63, v63, v14
  v_sub_f32 v64, v64, v14
  v_sub_f32 v65, v65, v14
  v_sub_f32 v66, v66, v14
  v_sub_f32 v67, v67, v14
  v_sub_f32 v68, v68, v14
  v_sub_f32 v69, v69, v14
  v_sub_f32 v70, v70, v14
  v_sub_f32 v71, v71, v14
  v_mul_f32 v56, s6, v56
  v_mul_f32 v57, s6, v57
  v_mul_f32 v58, s6, v58
  v_mul_f32 v59, s6, v59
  v_mul_f32 v60, s6, v60
  v_mul_f32 v61, s6, v61
  v_mul_f32 v62, s6, v62
  v_mul_f32 v63, s6, v63
  v_mul_f32 v64, s6, v64
  v_mul_f32 v65, s6, v65
  v_mul_f32 v66, s6, v66
  v_mul_f32 v67, s6, v67
  v_mul_f32 v68, s6, v68
  v_mul_f32 v69, s6, v69
  v_mul_f32 v70, s6, v70
  v_mul_f32 v71, s6, v71
  v_exp_f32 v56, v56
  v_exp_f32 v57, v57
  v_exp_f32 v58, v58
  v_exp_f32 v59, v59
  v_exp_f32 v60, v60
  v_exp_f32 v61, v61
  v_exp_f32 v62, v62
  v_exp_f32 v63, v63
  v_exp_f32 v64, v64
  v_exp_f32 v65, v65
  v_exp_f32 v66, v66
  v_exp_f32 v67, v67
  v_exp_f32 v68, v68
  v_exp_f32 v69, v69
  v_exp_f32 v70, v70
  v_exp_f32 v71, v71
  v_mul_f32 v56, v56, v15
  v_mul_f32 v57, v57, v15
  v_mul_f32 v58, v58, v15
  v_mul_f32 v59, v59, v15
  v_mul_f32 v60, v60, v15
  v_mul_f32 v61, v61, v15
  v_mul_f32 v62, v62, v15
  v_mul_f32 v63, v63, v15
  v_mul_f32 v64, v64, v15
  v_mul_f32 v65, v65, v15
  v_mul_f32 v66, v66, v15
  v_mul_f32 v67, v67, v15
  v_mul_f32 v68, v68, v15
  v_mul_f32 v69, v69, v15
  v_mul_f32 v70, v70, v15
  v_mul_f32 v71, v71, v15
  v_cvt_pk_bf16_f32 v56, v56, v56
  v_cvt_pk_bf16_f32 v57, v57, v57
  v_cvt_pk_bf16_f32 v58, v58, v58
  v_cvt_pk_bf16_f32 v59, v59, v59
  v_cvt_pk_bf16_f32 v60, v60, v60
  v_cvt_pk_bf16_f32 v61, v61, v61
  v_cvt_pk_bf16_f32 v62, v62, v62
  v_cvt_pk_bf16_f32 v63, v63, v63
  v_cvt_pk_bf16_f32 v64, v64, v64
  v_cvt_pk_bf16_f32 v65, v65, v65
  v_cvt_pk_bf16_f32 v66, v66, v66
  v_cvt_pk_bf16_f32 v67, v67, v67
  v_cvt_pk_bf16_f32 v68, v68, v68
  v_cvt_pk_bf16_f32 v69, v69, v69
  v_cvt_pk_bf16_f32 v70, v70, v70
  v_cvt_pk_bf16_f32 v71, v71, v71
  v_and_b32_dpp v36, v56, v20 quad_perm:[0,0,0,0] row_mask:0xf bank_mask:0xf
  v_and_b32_dpp v37, v56, v21 quad_perm:[0,0,0,0] row_mask:0xf bank_mask:0xf
  v_and_b32_dpp v38, v56, v22 quad_perm:[0,0,0,0] row_mask:0xf bank_mask:0xf
  v_and_b32_dpp v39, v56, v23 quad_perm:[0,0,0,0] row_mask:0xf bank_mask:0xf
  v_and_b32_dpp v40, v56, v20 quad_perm:[1,1,1,1] row_mask:0xf bank_mask:0xf
  v_and_b32_dpp v41, v56, v21 quad_perm:[1,1,1,1] row_mask:0xf bank_mask:0xf
  v_and_b32_dpp v42, v56, v22 quad_perm:[1,1,1,1] row_mask:0xf bank_mask:0xf
  v_and_b32_dpp v43, v56, v23 quad_perm:[1,1,1,1] row_mask:0xf bank_mask:0xf
  v_and_b32_dpp v44, v56, v20 quad_perm:[2,2,2,2] row_mask:0xf bank_mask:0xf
  v_and_b32_dpp v45, v56, v21 quad_perm:[2,2,2,2] row_mask:0xf bank_mask:0xf
  v_and_b32_dpp v46, v56, v22 quad_perm:[2,2,2,2] row_mask:0xf bank_mask:0xf
  v_and_b32_dpp v47, v56, v23 quad_perm:[2,2,2,2] row_mask:0xf bank_mask:0xf
  v_and_b32_dpp v48, v56, v20 quad_perm:[3,3,3,3] row_mask:0xf bank_mask:0xf
  v_and_b32_dpp v49, v56, v21 quad_perm:[3,3,3,3] row_mask:0xf bank_mask:0xf
  v_and_b32_dpp v50, v56, v22 quad_perm:[3,3,3,3] row_mask:0xf bank_mask:0xf
  v_and_b32_dpp v51, v56, v23 quad_perm:[3,3,3,3] row_mask:0xf bank_mask:0xf
  v_mfma_f32_16x16x32_bf16 v[24:27], v[36:39], v[88:91], v[24:27]
  v_mfma_f32_16x16x32_bf16 v[24:27], v[40:43], v[92:95], v[24:27]
  v_mfma_f32_16x16x32_bf16 v[24:27], v[44:47], v[96:99], v[24:27]
  v_mfma_f32_16x16x32_bf16 v[24:27], v[48:51], v[100:103], v[24:27]
  s_cmp_ge_u32 s21, 1
  s_cselect_b64 vcc, -1, 0
  s_cbranch_vccz RW_35
  s_waitcnt vmcnt(2)
RW_35:
  s_add_u32 s5, s4, 196608
  buffer_load_dwordx4 v[88:91], v2, s[12:15], s5 offen offset:0 nt
  v_and_b32_dpp v36, v57, v20 quad_perm:[0,0,0,0] row_mask:0xf bank_mask:0xf
  v_and_b32_dpp v37, v57, v21 quad_perm:[0,0,0,0] row_mask:0xf bank_mask:0xf
  v_and_b32_dpp v38, v57, v22 quad_perm:[0,0,0,0] row_mask:0xf bank_mask:0xf
  v_and_b32_dpp v39, v57, v23 quad_perm:[0,0,0,0] row_mask:0xf bank_mask:0xf
  v_and_b32_dpp v40, v57, v20 quad_perm:[1,1,1,1] row_mask:0xf bank_mask:0xf
  v_and_b32_dpp v41, v57, v21 quad_perm:[1,1,1,1] row_mask:0xf bank_mask:0xf
  v_and_b32_dpp v42, v57, v22 quad_perm:[1,1,1,1] row_mask:0xf bank_mask:0xf
  v_and_b32_dpp v43, v57, v23 quad_perm:[1,1,1,1] row_mask:0xf bank_mask:0xf
  v_and_b32_dpp v44, v57, v20 quad_perm:[2,2,2,2] row_mask:0xf bank_mask:0xf
  v_and_b32_dpp v45, v57, v21 quad_perm:[2,2,2,2] row_mask:0xf bank_mask:0xf
  v_and_b32_dpp v46, v57, v22 quad_perm:[2,2,2,2] row_mask:0xf bank_mask:0xf
  v_and_b32_dpp v47, v57, v23 quad_perm:[2,2,2,2] row_mask:0xf bank_mask:0xf
  v_and_b32_dpp v48, v57, v20 quad_perm:[3,3,3,3] row_mask:0xf bank_mask:0xf
  v_and_b32_dpp v49, v57, v21 quad_perm:[3,3,3,3] row_mask:0xf bank_mask:0xf
  v_and_b32_dpp v50, v57, v22 quad_perm:[3,3,3,3] row_mask:0xf bank_mask:0xf
  v_and_b32_dpp v51, v57, v23 quad_perm:[3,3,3,3] row_mask:0xf bank_mask:0xf
  v_mfma_f32_16x16x32_bf16 v[24:27], v[36:39], v[104:107], v[24:27]
  v_mfma_f32_16x16x32_bf16 v[24:27], v[40:43], v[108:111], v[24:27]
  v_mfma_f32_16x16x32_bf16 v[24:27], v[44:47], v[112:115], v[24:27]
  v_mfma_f32_16x16x32_bf16 v[24:27], v[48:51], v[116:119], v[24:27]
  s_waitcnt vmcnt(3)
  s_cbranch_vccz RW_36
  s_waitcnt vmcnt(2)
RW_36:
  buffer_load_dwordx4 v[92:95], v2, s[12:15], s5 offen offset:1024 nt
  v_and_b32_dpp v36, v58, v20 quad_perm:[0,0,0,0] row_mask:0xf bank_mask:0xf
  v_and_b32_dpp v37, v58, v21 quad_perm:[0,0,0,0] row_mask:0xf bank_mask:0xf
  v_and_b32_dpp v38, v58, v22 quad_perm:[0,0,0,0] row_mask:0xf bank_mask:0xf
  v_and_b32_dpp v39, v58, v23 quad_perm:[0,0,0,0] row_mask:0xf bank_mask:0xf
  v_and_b32_dpp v40, v58, v20 quad_perm:[1,1,1,1] row_mask:0xf bank_mask:0xf
  v_and_b32_dpp v41, v58, v21 quad_perm:[1,1,1,1] row_mask:0xf bank_mask:0xf
  v_and_b32_dpp v42, v58, v22 quad_perm:[1,1,1,1] row_mask:0xf bank_mask:0xf
  v_and_b32_dpp v43, v58, v23 quad_perm:[1,1,1,1] row_mask:0xf bank_mask:0xf
  v_and_b32_dpp v44, v58, v20 quad_perm:[2,2,2,2] row_mask:0xf bank_mask:0xf
  v_and_b32_dpp v45, v58, v21 quad_perm:[2,2,2,2] row_mask:0xf bank_mask:0xf
  v_and_b32_dpp v46, v58, v22 quad_perm:[2,2,2,2] row_mask:0xf bank_mask:0xf
  v_and_b32_dpp v47, v58, v23 quad_perm:[2,2,2,2] row_mask:0xf bank_mask:0xf
  v_and_b32_dpp v48, v58, v20 quad_perm:[3,3,3,3] row_mask:0xf bank_mask:0xf
  v_and_b32_dpp v49, v58, v21 quad_perm:[3,3,3,3] row_mask:0xf bank_mask:0xf
  v_and_b32_dpp v50, v58, v22 quad_perm:[3,3,3,3] row_mask:0xf bank_mask:0xf
  v_and_b32_dpp v51, v58, v23 quad_perm:[3,3,3,3] row_mask:0xf bank_mask:0xf
  v_mfma_f32_16x16x32_bf16 v[24:27], v[36:39], v[120:123], v[24:27]
  v_mfma_f32_16x16x32_bf16 v[24:27], v[40:43], v[124:127], v[24:27]
  v_mfma_f32_16x16x32_bf16 v[24:27], v[44:47], v[128:131], v[24:27]
  v_mfma_f32_16x16x32_bf16 v[24:27], v[48:51], v[132:135], v[24:27]
  s_waitcnt vmcnt(3)
  s_cbranch_vccz RW_37
  s_waitcnt vmcnt(2)
RW_37:
  buffer_load_dwordx4 v[96:99], v2, s[12:15], s5 offen offset:2048 nt
  v_and_b32_dpp v36, v59, v20 quad_perm:[0,0,0,0] row_mask:0xf bank_mask:0xf
  v_and_b32_dpp v37, v59, v21 quad_perm:[0,0,0,0] row_mask:0xf bank_mask:0xf
  v_and_b32_dpp v38, v59, v22 quad_perm:[0,0,0,0] row_mask:0xf bank_mask:0xf
  v_and_b32_dpp v39, v59, v23 quad_perm:[0,0,0,0] row_mask:0xf bank_mask:0xf
  v_and_b32_dpp v40, v59, v20 quad_perm:[1,1,1,1] row_mask:0xf bank_mask:0xf
  v_and_b32_dpp v41, v59, v21 quad_perm:[1,1,1,1] row_mask:0xf bank_mask:0xf
  v_and_b32_dpp v42, v59, v22 quad_perm:[1,1,1,1] row_mask:0xf bank_mask:0xf
  v_and_b32_dpp v43, v59, v23 quad_perm:[1,1,1,1] row_mask:0xf bank_mask:0xf
  v_and_b32_dpp v44, v59, v20 quad_perm:[2,2,2,2] row_mask:0xf bank_mask:0xf
  v_and_b32_dpp v45, v59, v21 quad_perm:[2,2,2,2] row_mask:0xf bank_mask:0xf
  v_and_b32_dpp v46, v59, v22 quad_perm:[2,2,2,2] row_mask:0xf bank_mask:0xf
  v_and_b32_dpp v47, v59, v23 quad_perm:[2,2,2,2] row_mask:0xf bank_mask:0xf
  v_and_b32_dpp v48, v59, v20 quad_perm:[3,3,3,3] row_mask:0xf bank_mask:0xf
  v_and_b32_dpp v49, v59, v21 quad_perm:[3,3,3,3] row_mask:0xf bank_mask:0xf
  v_and_b32_dpp v50, v59, v22 quad_perm:[3,3,3,3] row_mask:0xf bank_mask:0xf
  v_and_b32_dpp v51, v59, v23 quad_perm:[3,3,3,3] row_mask:0xf bank_mask:0xf
  v_mfma_f32_16x16x32_bf16 v[24:27], v[36:39], v[136:139], v[24:27]
  v_mfma_f32_16x16x32_bf16 v[24:27], v[40:43], v[140:143], v[24:27]
  v_mfma_f32_16x16x32_bf16 v[24:27], v[44:47], v[144:147], v[24:27]
  v_mfma_f32_16x16x32_bf16 v[24:27], v[48:51], v[148:151], v[24:27]
  s_waitcnt vmcnt(3)
  s_cbranch_vccz RW_38
  s_waitcnt vmcnt(2)
RW_38:
  buffer_load_dwordx4 v[100:103], v2, s[12:15], s5 offen offset:3072 nt
  v_and_b32_dpp v36, v60, v20 quad_perm:[0,0,0,0] row_mask:0xf bank_mask:0xf
  v_and_b32_dpp v37, v60, v21 quad_perm:[0,0,0,0] row_mask:0xf bank_mask:0xf
  v_and_b32_dpp v38, v60, v22 quad_perm:[0,0,0,0] row_mask:0xf bank_mask:0xf
  v_and_b32_dpp v39, v60, v23 quad_perm:[0,0,0,0] row_mask:0xf bank_mask:0xf
  v_and_b32_dpp v40, v60, v20 quad_perm:[1,1,1,1] row_mask:0xf bank_mask:0xf
  v_and_b32_dpp v41, v60, v21 quad_perm:[1,1,1,1] row_mask:0xf bank_mask:0xf
  v_and_b32_dpp v42, v60, v22 quad_perm:[1,1,1,1] row_mask:0xf bank_mask:0xf
  v_and_b32_dpp v43, v60, v23 quad_perm:[1,1,1,1] row_mask:0xf bank_mask:0xf
  v_and_b32_dpp v44, v60, v20 quad_perm:[2,2,2,2] row_mask:0xf bank_mask:0xf
  v_and_b32_dpp v45, v60, v21 quad_perm:[2,2,2,2] row_mask:0xf bank_mask:0xf
  v_and_b32_dpp v46, v60, v22 quad_perm:[2,2,2,2] row_mask:0xf bank_mask:0xf
  v_and_b32_dpp v47, v60, v23 quad_perm:[2,2,2,2] row_mask:0xf bank_mask:0xf
  v_and_b32_dpp v48, v60, v20 quad_perm:[3,3,3,3] row_mask:0xf bank_mask:0xf
  v_and_b32_dpp v49, v60, v21 quad_perm:[3,3,3,3] row_mask:0xf bank_mask:0xf
  v_and_b32_dpp v50, v60, v22 quad_perm:[3,3,3,3] row_mask:0xf bank_mask:0xf
  v_and_b32_dpp v51, v60, v23 quad_perm:[3,3,3,3] row_mask:0xf bank_mask:0xf
  v_mfma_f32_16x16x32_bf16 v[24:27], v[36:39], v[152:155], v[24:27]
  v_mfma_f32_16x16x32_bf16 v[24:27], v[40:43], v[156:159], v[24:27]
  v_mfma_f32_16x16x32_bf16 v[24:27], v[44:47], v[160:163], v[24:27]
  v_mfma_f32_16x16x32_bf16 v[24:27], v[48:51], v[164:167], v[24:27]
  s_waitcnt vmcnt(3)
  s_cbranch_vccz RW_39
  s_waitcnt vmcnt(2)
RW_39:
  s_add_u32 s5, s4, 229376
  buffer_load_dwordx4 v[104:107], v2, s[12:15], s5 offen offset:0 nt
  v_and_b32_dpp v36, v61, v20 quad_perm:[0,0,0,0] row_mask:0xf bank_mask:0xf
  v_and_b32_dpp v37, v61, v21 quad_perm:[0,0,0,0] row_mask:0xf bank_mask:0xf
  v_and_b32_dpp v38, v61, v22 quad_perm:[0,0,0,0] row_mask:0xf bank_mask:0xf
  v_and_b32_dpp v39, v61, v23 quad_perm:[0,0,0,0] row_mask:0xf bank_mask:0xf
  v_and_b32_dpp v40, v61, v20 quad_perm:[1,1,1,1] row_mask:0xf bank_mask:0xf
  v_and_b32_dpp v41, v61, v21 quad_perm:[1,1,1,1] row_mask:0xf bank_mask:0xf
  v_and_b32_dpp v42, v61, v22 quad_perm:[1,1,1,1] row_mask:0xf bank_mask:0xf
  v_and_b32_dpp v43, v61, v23 quad_perm:[1,1,1,1] row_mask:0xf bank_mask:0xf
  v_and_b32_dpp v44, v61, v20 quad_perm:[2,2,2,2] row_mask:0xf bank_mask:0xf
  v_and_b32_dpp v45, v61, v21 quad_perm:[2,2,2,2] row_mask:0xf bank_mask:0xf
  v_and_b32_dpp v46, v61, v22 quad_perm:[2,2,2,2] row_mask:0xf bank_mask:0xf
  v_and_b32_dpp v47, v61, v23 quad_perm:[2,2,2,2] row_mask:0xf bank_mask:0xf
  v_and_b32_dpp v48, v61, v20 quad_perm:[3,3,3,3] row_mask:0xf bank_mask:0xf
  v_and_b32_dpp v49, v61, v21 quad_perm:[3,3,3,3] row_mask:0xf bank_mask:0xf
  v_and_b32_dpp v50, v61, v22 quad_perm:[3,3,3,3] row_mask:0xf bank_mask:0xf
  v_and_b32_dpp v51, v61, v23 quad_perm:[3,3,3,3] row_mask:0xf bank_mask:0xf
  v_mfma_f32_16x16x32_bf16 v[24:27], v[36:39], v[72:75], v[24:27]
  v_mfma_f32_16x16x32_bf16 v[24:27], v[40:43], v[76:79], v[24:27]
  v_mfma_f32_16x16x32_bf16 v[24:27], v[44:47], v[80:83], v[24:27]
  v_mfma_f32_16x16x32_bf16 v[24:27], v[48:51], v[84:87], v[24:27]
  s_waitcnt vmcnt(3)
  s_cbranch_vccz RW_40
  s_waitcnt vmcnt(2)
RW_40:
  buffer_load_dwordx4 v[108:111], v2, s[12:15], s5 offen offset:1024 nt
  s_waitcnt vmcnt(3)
  s_cbranch_vccz RW_41
  s_waitcnt vmcnt(2)
RW_41:
  buffer_load_dwordx4 v[112:115], v2, s[12:15], s5 offen offset:2048 nt
  s_waitcnt vmcnt(3)
  s_cbranch_vccz RW_42
  s_waitcnt vmcnt(2)
RW_42:
  buffer_load_dwordx4 v[116:119], v2, s[12:15], s5 offen offset:3072 nt
  v_and_b32_dpp v36, v62, v20 quad_perm:[0,0,0,0] row_mask:0xf bank_mask:0xf
  v_and_b32_dpp v37, v62, v21 quad_perm:[0,0,0,0] row_mask:0xf bank_mask:0xf
  v_and_b32_dpp v38, v62, v22 quad_perm:[0,0,0,0] row_mask:0xf bank_mask:0xf
  v_and_b32_dpp v39, v62, v23 quad_perm:[0,0,0,0] row_mask:0xf bank_mask:0xf
  v_and_b32_dpp v40, v62, v20 quad_perm:[1,1,1,1] row_mask:0xf bank_mask:0xf
  v_and_b32_dpp v41, v62, v21 quad_perm:[1,1,1,1] row_mask:0xf bank_mask:0xf
  v_and_b32_dpp v42, v62, v22 quad_perm:[1,1,1,1] row_mask:0xf bank_mask:0xf
  v_and_b32_dpp v43, v62, v23 quad_perm:[1,1,1,1] row_mask:0xf bank_mask:0xf
  v_and_b32_dpp v44, v62, v20 quad_perm:[2,2,2,2] row_mask:0xf bank_mask:0xf
  v_and_b32_dpp v45, v62, v21 quad_perm:[2,2,2,2] row_mask:0xf bank_mask:0xf
  v_and_b32_dpp v46, v62, v22 quad_perm:[2,2,2,2] row_mask:0xf bank_mask:0xf
  v_and_b32_dpp v47, v62, v23 quad_perm:[2,2,2,2] row_mask:0xf bank_mask:0xf
  v_and_b32_dpp v48, v62, v20 quad_perm:[3,3,3,3] row_mask:0xf bank_mask:0xf
  v_and_b32_dpp v49, v62, v21 quad_perm:[3,3,3,3] row_mask:0xf bank_mask:0xf
  v_and_b32_dpp v50, v62, v22 quad_perm:[3,3,3,3] row_mask:0xf bank_mask:0xf
  v_and_b32_dpp v51, v62, v23 quad_perm:[3,3,3,3] row_mask:0xf bank_mask:0xf
  v_mfma_f32_16x16x32_bf16 v[24:27], v[36:39], v[88:91], v[24:27]
  v_mfma_f32_16x16x32_bf16 v[24:27], v[40:43], v[92:95], v[24:27]
  v_mfma_f32_16x16x32_bf16 v[24:27], v[44:47], v[96:99], v[24:27]
  v_mfma_f32_16x16x32_bf16 v[24:27], v[48:51], v[100:103], v[24:27]
  s_waitcnt vmcnt(3)
  s_cbranch_vccz RW_43
  s_waitcnt vmcnt(2)
RW_43:
  s_add_u32 s5, s4, 262144
  buffer_load_dwordx4 v[120:123], v2, s[12:15], s5 offen offset:0 nt
  s_waitcnt vmcnt(3)
  s_cbranch_vccz RW_44
  s_waitcnt vmcnt(2)
RW_44:
  buffer_load_dwordx4 v[124:127], v2, s[12:15], s5 offen offset:1024 nt
  s_cmp_ge_u32 s21, 2
  s_cselect_b64 vcc, -1, 0
  s_waitcnt vmcnt(3)
  s_cbranch_vccz RW_45
  s_waitcnt vmcnt(2)
RW_45:
  buffer_load_dwordx4 v[128:131], v2, s[12:15], s5 offen offset:2048 nt
  s_waitcnt vmcnt(3)
  s_cbranch_vccz RW_46
  s_waitcnt vmcnt(2)
RW_46:
  buffer_load_dwordx4 v[132:135], v2, s[12:15], s5 offen offset:3072 nt
  v_and_b32_dpp v36, v63, v20 quad_perm:[0,0,0,0] row_mask:0xf bank_mask:0xf
  v_and_b32_dpp v37, v63, v21 quad_perm:[0,0,0,0] row_mask:0xf bank_mask:0xf
  v_and_b32_dpp v38, v63, v22 quad_perm:[0,0,0,0] row_mask:0xf bank_mask:0xf
  v_and_b32_dpp v39, v63, v23 quad_perm:[0,0,0,0] row_mask:0xf bank_mask:0xf
  v_and_b32_dpp v40, v63, v20 quad_perm:[1,1,1,1] row_mask:0xf bank_mask:0xf
  v_and_b32_dpp v41, v63, v21 quad_perm:[1,1,1,1] row_mask:0xf bank_mask:0xf
  v_and_b32_dpp v42, v63, v22 quad_perm:[1,1,1,1] row_mask:0xf bank_mask:0xf
  v_and_b32_dpp v43, v63, v23 quad_perm:[1,1,1,1] row_mask:0xf bank_mask:0xf
  v_and_b32_dpp v44, v63, v20 quad_perm:[2,2,2,2] row_mask:0xf bank_mask:0xf
  v_and_b32_dpp v45, v63, v21 quad_perm:[2,2,2,2] row_mask:0xf bank_mask:0xf
  v_and_b32_dpp v46, v63, v22 quad_perm:[2,2,2,2] row_mask:0xf bank_mask:0xf
  v_and_b32_dpp v47, v63, v23 quad_perm:[2,2,2,2] row_mask:0xf bank_mask:0xf
  v_and_b32_dpp v48, v63, v20 quad_perm:[3,3,3,3] row_mask:0xf bank_mask:0xf
  v_and_b32_dpp v49, v63, v21 quad_perm:[3,3,3,3] row_mask:0xf bank_mask:0xf
  v_and_b32_dpp v50, v63, v22 quad_perm:[3,3,3,3] row_mask:0xf bank_mask:0xf
  v_and_b32_dpp v51, v63, v23 quad_perm:[3,3,3,3] row_mask:0xf bank_mask:0xf
  v_mfma_f32_16x16x32_bf16 v[24:27], v[36:39], v[104:107], v[24:27]
  v_mfma_f32_16x16x32_bf16 v[24:27], v[40:43], v[108:111], v[24:27]
  v_mfma_f32_16x16x32_bf16 v[24:27], v[44:47], v[112:115], v[24:27]
  v_mfma_f32_16x16x32_bf16 v[24:27], v[48:51], v[116:119], v[24:27]
  s_waitcnt vmcnt(3)
  s_cbranch_vccz RW_47
  s_waitcnt vmcnt(2)
RW_47:
  s_add_u32 s5, s4, 294912
  buffer_load_dwordx4 v[136:139], v2, s[12:15], s5 offen offset:0 nt
  s_waitcnt vmcnt(3)
  s_cbranch_vccz RW_48
  s_waitcnt vmcnt(2)
RW_48:
  buffer_load_dwordx4 v[140:143], v2, s[12:15], s5 offen offset:1024 nt
  s_waitcnt vmcnt(3)
  s_cbranch_vccz RW_49
  s_waitcnt vmcnt(2)
RW_49:
  buffer_load_dwordx4 v[144:147], v2, s[12:15], s5 offen offset:2048 nt
  s_waitcnt vmcnt(3)
  s_cbranch_vccz RW_50
  s_waitcnt vmcnt(2)
RW_50:
  buffer_load_dwordx4 v[148:151], v2, s[12:15], s5 offen offset:3072 nt
  v_and_b32_dpp v36, v64, v20 quad_perm:[0,0,0,0] row_mask:0xf bank_mask:0xf
  v_and_b32_dpp v37, v64, v21 quad_perm:[0,0,0,0] row_mask:0xf bank_mask:0xf
  v_and_b32_dpp v38, v64, v22 quad_perm:[0,0,0,0] row_mask:0xf bank_mask:0xf
  v_and_b32_dpp v39, v64, v23 quad_perm:[0,0,0,0] row_mask:0xf bank_mask:0xf
  v_and_b32_dpp v40, v64, v20 quad_perm:[1,1,1,1] row_mask:0xf bank_mask:0xf
  v_and_b32_dpp v41, v64, v21 quad_perm:[1,1,1,1] row_mask:0xf bank_mask:0xf
  v_and_b32_dpp v42, v64, v22 quad_perm:[1,1,1,1] row_mask:0xf bank_mask:0xf
  v_and_b32_dpp v43, v64, v23 quad_perm:[1,1,1,1] row_mask:0xf bank_mask:0xf
  v_and_b32_dpp v44, v64, v20 quad_perm:[2,2,2,2] row_mask:0xf bank_mask:0xf
  v_and_b32_dpp v45, v64, v21 quad_perm:[2,2,2,2] row_mask:0xf bank_mask:0xf
  v_and_b32_dpp v46, v64, v22 quad_perm:[2,2,2,2] row_mask:0xf bank_mask:0xf
  v_and_b32_dpp v47, v64, v23 quad_perm:[2,2,2,2] row_mask:0xf bank_mask:0xf
  v_and_b32_dpp v48, v64, v20 quad_perm:[3,3,3,3] row_mask:0xf bank_mask:0xf
  v_and_b32_dpp v49, v64, v21 quad_perm:[3,3,3,3] row_mask:0xf bank_mask:0xf
  v_and_b32_dpp v50, v64, v22 quad_perm:[3,3,3,3] row_mask:0xf bank_mask:0xf
  v_and_b32_dpp v51, v64, v23 quad_perm:[3,3,3,3] row_mask:0xf bank_mask:0xf
  v_mfma_f32_16x16x32_bf16 v[24:27], v[36:39], v[120:123], v[24:27]
  v_mfma_f32_16x16x32_bf16 v[24:27], v[40:43], v[124:127], v[24:27]
  v_mfma_f32_16x16x32_bf16 v[24:27], v[44:47], v[128:131], v[24:27]
  v_mfma_f32_16x16x32_bf16 v[24:27], v[48:51], v[132:135], v[24:27]
  s_waitcnt vmcnt(3)
  s_cbranch_vccz RW_51
  s_waitcnt vmcnt(2)
RW_51:
  s_add_u32 s5, s4, 327680
  buffer_load_dwordx4 v[152:155], v2, s[12:15], s5 offen offset:0 nt
  s_waitcnt vmcnt(3)
  s_cbranch_vccz RW_52
  s_waitcnt vmcnt(2)
RW_52:
  buffer_load_dwordx4 v[156:159], v2, s[12:15], s5 offen offset:1024 nt
  s_waitcnt vmcnt(3)
  s_cbranch_vccz RW_53
  s_waitcnt vmcnt(2)
RW_53:
  buffer_load_dwordx4 v[160:163], v2, s[12:15], s5 offen offset:2048 nt
  s_waitcnt vmcnt(3)
  s_cbranch_vccz RW_54
  s_waitcnt vmcnt(2)
RW_54:
  buffer_load_dwordx4 v[164:167], v2, s[12:15], s5 offen offset:3072 nt
  v_and_b32_dpp v36, v65, v20 quad_perm:[0,0,0,0] row_mask:0xf bank_mask:0xf
  v_and_b32_dpp v37, v65, v21 quad_perm:[0,0,0,0] row_mask:0xf bank_mask:0xf
  v_and_b32_dpp v38, v65, v22 quad_perm:[0,0,0,0] row_mask:0xf bank_mask:0xf
  v_and_b32_dpp v39, v65, v23 quad_perm:[0,0,0,0] row_mask:0xf bank_mask:0xf
  v_and_b32_dpp v40, v65, v20 quad_perm:[1,1,1,1] row_mask:0xf bank_mask:0xf
  v_and_b32_dpp v41, v65, v21 quad_perm:[1,1,1,1] row_mask:0xf bank_mask:0xf
  v_and_b32_dpp v42, v65, v22 quad_perm:[1,1,1,1] row_mask:0xf bank_mask:0xf
  v_and_b32_dpp v43, v65, v23 quad_perm:[1,1,1,1] row_mask:0xf bank_mask:0xf
  v_and_b32_dpp v44, v65, v20 quad_perm:[2,2,2,2] row_mask:0xf bank_mask:0xf
  v_and_b32_dpp v45, v65, v21 quad_perm:[2,2,2,2] row_mask:0xf bank_mask:0xf
  v_and_b32_dpp v46, v65, v22 quad_perm:[2,2,2,2] row_mask:0xf bank_mask:0xf
  v_and_b32_dpp v47, v65, v23 quad_perm:[2,2,2,2] row_mask:0xf bank_mask:0xf
  v_and_b32_dpp v48, v65, v20 quad_perm:[3,3,3,3] row_mask:0xf bank_mask:0xf
  v_and_b32_dpp v49, v65, v21 quad_perm:[3,3,3,3] row_mask:0xf bank_mask:0xf
  v_and_b32_dpp v50, v65, v22 quad_perm:[3,3,3,3] row_mask:0xf bank_mask:0xf
  v_and_b32_dpp v51, v65, v23 quad_perm:[3,3,3,3] row_mask:0xf bank_mask:0xf
  v_mfma_f32_16x16x32_bf16 v[24:27], v[36:39], v[136:139], v[24:27]
  v_mfma_f32_16x16x32_bf16 v[24:27], v[40:43], v[140:143], v[24:27]
  v_mfma_f32_16x16x32_bf16 v[24:27], v[44:47], v[144:147], v[24:27]
  v_mfma_f32_16x16x32_bf16 v[24:27], v[48:51], v[148:151], v[24:27]
  s_cmp_ge_u32 s21, 3
  s_cselect_b64 vcc, -1, 0
  s_waitcnt vmcnt(3)
  s_cbranch_vccz RW_55
  s_waitcnt vmcnt(2)
RW_55:
  s_add_u32 s5, s4, 360448
  buffer_load_dwordx4 v[72:75], v2, s[12:15], s5 offen offset:0 nt
  s_waitcnt vmcnt(3)
  s_cbranch_vccz RW_56
  s_waitcnt vmcnt(2)
RW_56:
  buffer_load_dwordx4 v[76:79], v2, s[12:15], s5 offen offset:1024 nt
  s_waitcnt vmcnt(3)
  s_cbranch_vccz RW_57
  s_waitcnt vmcnt(2)
RW_57:
  buffer_load_dwordx4 v[80:83], v2, s[12:15], s5 offen offset:2048 nt
  s_waitcnt vmcnt(3)
  s_cbranch_vccz RW_58
  s_waitcnt vmcnt(2)
RW_58:
  buffer_load_dwordx4 v[84:87], v2, s[12:15], s5 offen offset:3072 nt
  v_and_b32_dpp v36, v66, v20 quad_perm:[0,0,0,0] row_mask:0xf bank_mask:0xf
  v_and_b32_dpp v37, v66, v21 quad_perm:[0,0,0,0] row_mask:0xf bank_mask:0xf
  v_and_b32_dpp v38, v66, v22 quad_perm:[0,0,0,0] row_mask:0xf bank_mask:0xf
  v_and_b32_dpp v39, v66, v23 quad_perm:[0,0,0,0] row_mask:0xf bank_mask:0xf
  v_and_b32_dpp v40, v66, v20 quad_perm:[1,1,1,1] row_mask:0xf bank_mask:0xf
  v_and_b32_dpp v41, v66, v21 quad_perm:[1,1,1,1] row_mask:0xf bank_mask:0xf
  v_and_b32_dpp v42, v66, v22 quad_perm:[1,1,1,1] row_mask:0xf bank_mask:0xf
  v_and_b32_dpp v43, v66, v23 quad_perm:[1,1,1,1] row_mask:0xf bank_mask:0xf
  v_and_b32_dpp v44, v66, v20 quad_perm:[2,2,2,2] row_mask:0xf bank_mask:0xf
  v_and_b32_dpp v45, v66, v21 quad_perm:[2,2,2,2] row_mask:0xf bank_mask:0xf
  v_and_b32_dpp v46, v66, v22 quad_perm:[2,2,2,2] row_mask:0xf bank_mask:0xf
  v_and_b32_dpp v47, v66, v23 quad_perm:[2,2,2,2] row_mask:0xf bank_mask:0xf
  v_and_b32_dpp v48, v66, v20 quad_perm:[3,3,3,3] row_mask:0xf bank_mask:0xf
  v_and_b32_dpp v49, v66, v21 quad_perm:[3,3,3,3] row_mask:0xf bank_mask:0xf
  v_and_b32_dpp v50, v66, v22 quad_perm:[3,3,3,3] row_mask:0xf bank_mask:0xf
  v_and_b32_dpp v51, v66, v23 quad_perm:[3,3,3,3] row_mask:0xf bank_mask:0xf
  v_mfma_f32_16x16x32_bf16 v[24:27], v[36:39], v[152:155], v[24:27]
  v_mfma_f32_16x16x32_bf16 v[24:27], v[40:43], v[156:159], v[24:27]
  v_mfma_f32_16x16x32_bf16 v[24:27], v[44:47], v[160:163], v[24:27]
  v_mfma_f32_16x16x32_bf16 v[24:27], v[48:51], v[164:167], v[24:27]
  s_waitcnt vmcnt(3)
  s_cbranch_vccz RW_59
  s_waitcnt vmcnt(2)
RW_59:
  s_add_u32 s5, s4, 393216
  buffer_load_dwordx4 v[88:91], v2, s[12:15], s5 offen offset:0 nt
  s_waitcnt vmcnt(3)
  s_cbranch_vccz RW_60
  s_waitcnt vmcnt(2)
RW_60:
  buffer_load_dwordx4 v[92:95], v2, s[12:15], s5 offen offset:1024 nt
  s_waitcnt vmcnt(3)
  s_cbranch_vccz RW_61
  s_waitcnt vmcnt(2)
RW_61:
  buffer_load_dwordx4 v[96:99], v2, s[12:15], s5 offen offset:2048 nt
  s_waitcnt vmcnt(3)
  s_cbranch_vccz RW_62
  s_waitcnt vmcnt(2)
RW_62:
  buffer_load_dwordx4 v[100:103], v2, s[12:15], s5 offen offset:3072 nt
  v_and_b32_dpp v36, v67, v20 quad_perm:[0,0,0,0] row_mask:0xf bank_mask:0xf
  v_and_b32_dpp v37, v67, v21 quad_perm:[0,0,0,0] row_mask:0xf bank_mask:0xf
  v_and_b32_dpp v38, v67, v22 quad_perm:[0,0,0,0] row_mask:0xf bank_mask:0xf
  v_and_b32_dpp v39, v67, v23 quad_perm:[0,0,0,0] row_mask:0xf bank_mask:0xf
  v_and_b32_dpp v40, v67, v20 quad_perm:[1,1,1,1] row_mask:0xf bank_mask:0xf
  v_and_b32_dpp v41, v67, v21 quad_perm:[1,1,1,1] row_mask:0xf bank_mask:0xf
  v_and_b32_dpp v42, v67, v22 quad_perm:[1,1,1,1] row_mask:0xf bank_mask:0xf
  v_and_b32_dpp v43, v67, v23 quad_perm:[1,1,1,1] row_mask:0xf bank_mask:0xf
  v_and_b32_dpp v44, v67, v20 quad_perm:[2,2,2,2] row_mask:0xf bank_mask:0xf
  v_and_b32_dpp v45, v67, v21 quad_perm:[2,2,2,2] row_mask:0xf bank_mask:0xf
  v_and_b32_dpp v46, v67, v22 quad_perm:[2,2,2,2] row_mask:0xf bank_mask:0xf
  v_and_b32_dpp v47, v67, v23 quad_perm:[2,2,2,2] row_mask:0xf bank_mask:0xf
  v_and_b32_dpp v48, v67, v20 quad_perm:[3,3,3,3] row_mask:0xf bank_mask:0xf
  v_and_b32_dpp v49, v67, v21 quad_perm:[3,3,3,3] row_mask:0xf bank_mask:0xf
  v_and_b32_dpp v50, v67, v22 quad_perm:[3,3,3,3] row_mask:0xf bank_mask:0xf
  v_and_b32_dpp v51, v67, v23 quad_perm:[3,3,3,3] row_mask:0xf bank_mask:0xf
  v_mfma_f32_16x16x32_bf16 v[24:27], v[36:39], v[72:75], v[24:27]
  v_mfma_f32_16x16x32_bf16 v[24:27], v[40:43], v[76:79], v[24:27]
  v_mfma_f32_16x16x32_bf16 v[24:27], v[44:47], v[80:83], v[24:27]
  v_mfma_f32_16x16x32_bf16 v[24:27], v[48:51], v[84:87], v[24:27]
  s_waitcnt vmcnt(3)
  s_cbranch_vccz RW_63
  s_waitcnt vmcnt(2)
RW_63:
  s_add_u32 s5, s4, 425984
  buffer_load_dwordx4 v[104:107], v2, s[12:15], s5 offen offset:0 nt
  s_waitcnt vmcnt(3)
  s_cbranch_vccz RW_64
  s_waitcnt vmcnt(2)
RW_64:
  buffer_load_dwordx4 v[108:111], v2, s[12:15], s5 offen offset:1024 nt
  s_cmp_ge_u32 s21, 4
  s_cselect_b64 vcc, -1, 0
  s_waitcnt vmcnt(3)
  s_cbranch_vccz RW_65
  s_waitcnt vmcnt(2)
RW_65:
  buffer_load_dwordx4 v[112:115], v2, s[12:15], s5 offen offset:2048 nt
  s_waitcnt vmcnt(3)
  s_cbranch_vccz RW_66
  s_waitcnt vmcnt(2)
RW_66:
  buffer_load_dwordx4 v[116:119], v2, s[12:15], s5 offen offset:3072 nt
  v_and_b32_dpp v36, v68, v20 quad_perm:[0,0,0,0] row_mask:0xf bank_mask:0xf
  v_and_b32_dpp v37, v68, v21 quad_perm:[0,0,0,0] row_mask:0xf bank_mask:0xf
  v_and_b32_dpp v38, v68, v22 quad_perm:[0,0,0,0] row_mask:0xf bank_mask:0xf
  v_and_b32_dpp v39, v68, v23 quad_perm:[0,0,0,0] row_mask:0xf bank_mask:0xf
  v_and_b32_dpp v40, v68, v20 quad_perm:[1,1,1,1] row_mask:0xf bank_mask:0xf
  v_and_b32_dpp v41, v68, v21 quad_perm:[1,1,1,1] row_mask:0xf bank_mask:0xf
  v_and_b32_dpp v42, v68, v22 quad_perm:[1,1,1,1] row_mask:0xf bank_mask:0xf
  v_and_b32_dpp v43, v68, v23 quad_perm:[1,1,1,1] row_mask:0xf bank_mask:0xf
  v_and_b32_dpp v44, v68, v20 quad_perm:[2,2,2,2] row_mask:0xf bank_mask:0xf
  v_and_b32_dpp v45, v68, v21 quad_perm:[2,2,2,2] row_mask:0xf bank_mask:0xf
  v_and_b32_dpp v46, v68, v22 quad_perm:[2,2,2,2] row_mask:0xf bank_mask:0xf
  v_and_b32_dpp v47, v68, v23 quad_perm:[2,2,2,2] row_mask:0xf bank_mask:0xf
  v_and_b32_dpp v48, v68, v20 quad_perm:[3,3,3,3] row_mask:0xf bank_mask:0xf
  v_and_b32_dpp v49, v68, v21 quad_perm:[3,3,3,3] row_mask:0xf bank_mask:0xf
  v_and_b32_dpp v50, v68, v22 quad_perm:[3,3,3,3] row_mask:0xf bank_mask:0xf
  v_and_b32_dpp v51, v68, v23 quad_perm:[3,3,3,3] row_mask:0xf bank_mask:0xf
  v_mfma_f32_16x16x32_bf16 v[24:27], v[36:39], v[88:91], v[24:27]
  v_mfma_f32_16x16x32_bf16 v[24:27], v[40:43], v[92:95], v[24:27]
  v_mfma_f32_16x16x32_bf16 v[24:27], v[44:47], v[96:99], v[24:27]
  v_mfma_f32_16x16x32_bf16 v[24:27], v[48:51], v[100:103], v[24:27]
  s_waitcnt vmcnt(3)
  s_cbranch_vccz RW_67
  s_waitcnt vmcnt(2)
RW_67:
  s_add_u32 s5, s4, 458752
  buffer_load_dwordx4 v[120:123], v2, s[12:15], s5 offen offset:0 nt
  s_waitcnt vmcnt(3)
  s_cbranch_vccz RW_68
  s_waitcnt vmcnt(2)
RW_68:
  buffer_load_dwordx4 v[124:127], v2, s[12:15], s5 offen offset:1024 nt
  s_waitcnt vmcnt(3)
  s_cbranch_vccz RW_69
  s_waitcnt vmcnt(2)
RW_69:
  buffer_load_dwordx4 v[128:131], v2, s[12:15], s5 offen offset:2048 nt
  s_waitcnt vmcnt(3)
  s_cbranch_vccz RW_70
  s_waitcnt vmcnt(2)
RW_70:
  buffer_load_dwordx4 v[132:135], v2, s[12:15], s5 offen offset:3072 nt
  v_and_b32_dpp v36, v69, v20 quad_perm:[0,0,0,0] row_mask:0xf bank_mask:0xf
  v_and_b32_dpp v37, v69, v21 quad_perm:[0,0,0,0] row_mask:0xf bank_mask:0xf
  v_and_b32_dpp v38, v69, v22 quad_perm:[0,0,0,0] row_mask:0xf bank_mask:0xf
  v_and_b32_dpp v39, v69, v23 quad_perm:[0,0,0,0] row_mask:0xf bank_mask:0xf
  v_and_b32_dpp v40, v69, v20 quad_perm:[1,1,1,1] row_mask:0xf bank_mask:0xf
  v_and_b32_dpp v41, v69, v21 quad_perm:[1,1,1,1] row_mask:0xf bank_mask:0xf
  v_and_b32_dpp v42, v69, v22 quad_perm:[1,1,1,1] row_mask:0xf bank_mask:0xf
  v_and_b32_dpp v43, v69, v23 quad_perm:[1,1,1,1] row_mask:0xf bank_mask:0xf
  v_and_b32_dpp v44, v69, v20 quad_perm:[2,2,2,2] row_mask:0xf bank_mask:0xf
  v_and_b32_dpp v45, v69, v21 quad_perm:[2,2,2,2] row_mask:0xf bank_mask:0xf
  v_and_b32_dpp v46, v69, v22 quad_perm:[2,2,2,2] row_mask:0xf bank_mask:0xf
  v_and_b32_dpp v47, v69, v23 quad_perm:[2,2,2,2] row_mask:0xf bank_mask:0xf
  v_and_b32_dpp v48, v69, v20 quad_perm:[3,3,3,3] row_mask:0xf bank_mask:0xf
  v_and_b32_dpp v49, v69, v21 quad_perm:[3,3,3,3] row_mask:0xf bank_mask:0xf
  v_and_b32_dpp v50, v69, v22 quad_perm:[3,3,3,3] row_mask:0xf bank_mask:0xf
  v_and_b32_dpp v51, v69, v23 quad_perm:[3,3,3,3] row_mask:0xf bank_mask:0xf
  v_mfma_f32_16x16x32_bf16 v[24:27], v[36:39], v[104:107], v[24:27]
  v_mfma_f32_16x16x32_bf16 v[24:27], v[40:43], v[108:111], v[24:27]
  v_mfma_f32_16x16x32_bf16 v[24:27], v[44:47], v[112:115], v[24:27]
  v_mfma_f32_16x16x32_bf16 v[24:27], v[48:51], v[116:119], v[24:27]
  s_waitcnt vmcnt(3)
  s_cbranch_vccz RW_71
  s_waitcnt vmcnt(2)
RW_71:
  s_add_u32 s5, s4, 491520
  buffer_load_dwordx4 v[136:139], v2, s[12:15], s5 offen offset:0 nt
  s_waitcnt vmcnt(3)
  s_cbranch_vccz RW_72
  s_waitcnt vmcnt(2)
RW_72:
  buffer_load_dwordx4 v[140:143], v2, s[12:15], s5 offen offset:1024 nt
  s_waitcnt vmcnt(3)
  s_cbranch_vccz RW_73
  s_waitcnt vmcnt(2)
RW_73:
  buffer_load_dwordx4 v[144:147], v2, s[12:15], s5 offen offset:2048 nt
  s_waitcnt vmcnt(3)
  s_cbranch_vccz RW_74
  s_waitcnt vmcnt(2)
RW_74:
  buffer_load_dwordx4 v[148:151], v2, s[12:15], s5 offen offset:3072 nt
  v_and_b32_dpp v36, v70, v20 quad_perm:[0,0,0,0] row_mask:0xf bank_mask:0xf
  v_and_b32_dpp v37, v70, v21 quad_perm:[0,0,0,0] row_mask:0xf bank_mask:0xf
  v_and_b32_dpp v38, v70, v22 quad_perm:[0,0,0,0] row_mask:0xf bank_mask:0xf
  v_and_b32_dpp v39, v70, v23 quad_perm:[0,0,0,0] row_mask:0xf bank_mask:0xf
  v_and_b32_dpp v40, v70, v20 quad_perm:[1,1,1,1] row_mask:0xf bank_mask:0xf
  v_and_b32_dpp v41, v70, v21 quad_perm:[1,1,1,1] row_mask:0xf bank_mask:0xf
  v_and_b32_dpp v42, v70, v22 quad_perm:[1,1,1,1] row_mask:0xf bank_mask:0xf
  v_and_b32_dpp v43, v70, v23 quad_perm:[1,1,1,1] row_mask:0xf bank_mask:0xf
  v_and_b32_dpp v44, v70, v20 quad_perm:[2,2,2,2] row_mask:0xf bank_mask:0xf
  v_and_b32_dpp v45, v70, v21 quad_perm:[2,2,2,2] row_mask:0xf bank_mask:0xf
  v_and_b32_dpp v46, v70, v22 quad_perm:[2,2,2,2] row_mask:0xf bank_mask:0xf
  v_and_b32_dpp v47, v70, v23 quad_perm:[2,2,2,2] row_mask:0xf bank_mask:0xf
  v_and_b32_dpp v48, v70, v20 quad_perm:[3,3,3,3] row_mask:0xf bank_mask:0xf
  v_and_b32_dpp v49, v70, v21 quad_perm:[3,3,3,3] row_mask:0xf bank_mask:0xf
  v_and_b32_dpp v50, v70, v22 quad_perm:[3,3,3,3] row_mask:0xf bank_mask:0xf
  v_and_b32_dpp v51, v70, v23 quad_perm:[3,3,3,3] row_mask:0xf bank_mask:0xf
  v_mfma_f32_16x16x32_bf16 v[24:27], v[36:39], v[120:123], v[24:27]
  v_mfma_f32_16x16x32_bf16 v[24:27], v[40:43], v[124:127], v[24:27]
  v_mfma_f32_16x16x32_bf16 v[24:27], v[44:47], v[128:131], v[24:27]
  v_mfma_f32_16x16x32_bf16 v[24:27], v[48:51], v[132:135], v[24:27]
  s_waitcnt vmcnt(0)
  v_and_b32_dpp v36, v71, v20 quad_perm:[0,0,0,0] row_mask:0xf bank_mask:0xf
  v_and_b32_dpp v37, v71, v21 quad_perm:[0,0,0,0] row_mask:0xf bank_mask:0xf
  v_and_b32_dpp v38, v71, v22 quad_perm:[0,0,0,0] row_mask:0xf bank_mask:0xf
  v_and_b32_dpp v39, v71, v23 quad_perm:[0,0,0,0] row_mask:0xf bank_mask:0xf
  v_and_b32_dpp v40, v71, v20 quad_perm:[1,1,1,1] row_mask:0xf bank_mask:0xf
  v_and_b32_dpp v41, v71, v21 quad_perm:[1,1,1,1] row_mask:0xf bank_mask:0xf
  v_and_b32_dpp v42, v71, v22 quad_perm:[1,1,1,1] row_mask:0xf bank_mask:0xf
  v_and_b32_dpp v43, v71, v23 quad_perm:[1,1,1,1] row_mask:0xf bank_mask:0xf
  v_and_b32_dpp v44, v71, v20 quad_perm:[2,2,2,2] row_mask:0xf bank_mask:0xf
  v_and_b32_dpp v45, v71, v21 quad_perm:[2,2,2,2] row_mask:0xf bank_mask:0xf
  v_and_b32_dpp v46, v71, v22 quad_perm:[2,2,2,2] row_mask:0xf bank_mask:0xf
  v_and_b32_dpp v47, v71, v23 quad_perm:[2,2,2,2] row_mask:0xf bank_mask:0xf
  v_and_b32_dpp v48, v71, v20 quad_perm:[3,3,3,3] row_mask:0xf bank_mask:0xf
  v_and_b32_dpp v49, v71, v21 quad_perm:[3,3,3,3] row_mask:0xf bank_mask:0xf
  v_and_b32_dpp v50, v71, v22 quad_perm:[3,3,3,3] row_mask:0xf bank_mask:0xf
  v_and_b32_dpp v51, v71, v23 quad_perm:[3,3,3,3] row_mask:0xf bank_mask:0xf
  v_mfma_f32_16x16x32_bf16 v[24:27], v[36:39], v[136:139], v[24:27]
  v_mfma_f32_16x16x32_bf16 v[24:27], v[40:43], v[140:143], v[24:27]
  v_mfma_f32_16x16x32_bf16 v[24:27], v[44:47], v[144:147], v[24:27]
  v_mfma_f32_16x16x32_bf16 v[24:27], v[48:51], v[148:151], v[24:27]
  s_nop 7
  ds_write_b128 v12, v[24:27] offset:2048
  s_mov_b64 exec, 1
  v_mov_b32 v15, 1
  s_waitcnt lgkmcnt(0)
  ds_add_rtn_u32 v13, v7, v15 offset:12
  s_waitcnt lgkmcnt(0)
  v_readfirstlane_b32 s91, v13
  s_mov_b64 exec, -1
  s_nop 2
  s_cmp_eq_u32 s91, 7
  s_cbranch_scc0 L_STREAM_END
  ds_read_b128 v[72:75], v2 offset:2048
  ds_read_b128 v[76:79], v2 offset:3072
  ds_read_b128 v[80:83], v2 offset:4096
  ds_read_b128 v[84:87], v2 offset:5120
  ds_read_b128 v[88:91], v2 offset:6144
  ds_read_b128 v[92:95], v2 offset:7168
  ds_read_b128 v[96:99], v2 offset:8192
  ds_read_b128 v[100:103], v2 offset:9216
  s_lshl_b32 s5, s99, 10
  s_add_u32 s5, s5, 65536
  s_waitcnt lgkmcnt(0)
  v_add_f32 v72, v72, v88
  v_add_f32 v73, v73, v89
  v_add_f32 v74, v74, v90
  v_add_f32 v75, v75, v91
  v_add_f32 v76, v76, v92
  v_add_f32 v77, v77, v93
  v_add_f32 v78, v78, v94
  v_add_f32 v79, v79, v95
  v_add_f32 v80, v80, v96
  v_add_f32 v81, v81, v97
  v_add_f32 v82, v82, v98
  v_add_f32 v83, v83, v99
  v_add_f32 v84, v84, v100
  v_add_f32 v85, v85, v101
  v_add_f32 v86, v86, v102
  v_add_f32 v87, v87, v103
  v_add_f32 v72, v72, v80
  v_add_f32 v73, v73, v81
  v_add_f32 v74, v74, v82
  v_add_f32 v75, v75, v83
  v_add_f32 v76, v76, v84
  v_add_f32 v77, v77, v85
  v_add_f32 v78, v78, v86
  v_add_f32 v79, v79, v87
  v_add_f32 v72, v72, v76
  v_add_f32 v73, v73, v77
  v_add_f32 v74, v74, v78
  v_add_f32 v75, v75, v79
  v_or_b32 v72, 1, v72
  v_or_b32 v73, 1, v73
  v_or_b32 v74, 1, v74
  v_or_b32 v75, 1, v75
  buffer_store_dwordx4 v[72:75], v2, s[16:19], s5 offen sc1
  v_mov_b32 v16, 8
  ds_write_b32 v7, v16 offset:40
L_STREAM_END:
  s_endpgm
L_AUX:
  s_setprio 2
  s_load_dwordx2 s[20:21], s[0:1], 24
  s_load_dwordx2 s[24:25], s[0:1], 32
  s_load_dwordx2 s[28:29], s[0:1], 48
  s_load_dwordx2 s[32:33], s[0:1], 56
  s_load_dwordx2 s[36:37], s[0:1], 64
  s_load_dwordx2 s[40:41], s[0:1], 80
  s_load_dwordx2 s[44:45], s[0:1], 0
  s_load_dwordx2 s[48:49], s[0:1], 72
  s_load_dwordx2 s[52:53], s[0:1], 88
  s_mov_b32 s22, 4718592
  s_mov_b32 s23, 0x20000
  s_mov_b32 s26, 4718592
  s_mov_b32 s27, 0x20000
  s_mov_b32 s30, 5308416
  s_mov_b32 s31, 0x20000
  s_mov_b32 s34, 5308416
  s_mov_b32 s35, 0x20000
  s_mov_b32 s38, 5308416
  s_mov_b32 s39, 0x20000
  s_mov_b32 s42, 3981312
  s_mov_b32 s43, 0x20000
  s_mov_b32 s46, 1152
  s_mov_b32 s47, 0x20000
  s_mov_b32 s50, 1152
  s_mov_b32 s51, 0x20000
  s_mov_b32 s54, 1152
  s_mov_b32 s55, 0x20000
  s_sub_u32 s57, s3, 8
  v_mov_b32 v9, 0
  v_lshlrev_b32 v22, 2, v0
  s_cmp_lg_u32 s57, 0
  s_cbranch_scc1 L_A_NOINIT
  s_mov_b32 exec_lo, -1
  s_mov_b32 exec_hi, 0
  ds_write_b32 v22, v9
  s_mov_b64 exec, -1
L_A_NOINIT:
  v_lshrrev_b32 v23, 3, v0
  v_mul_u32_u24 v1, 80, v23
  s_mul_i32 s58, s57, 640
  s_add_u32 s58, s58, 10240
  v_add_u32 v1, s58, v1
  v_and_b32 v23, 1, v0
  v_mul_u32_u24 v2, 320, v23
  v_lshrrev_b32 v23, 1, v0
  v_lshl_add_u32 v2, v23, 2, v2
  v_add_u32 v2, s58, v2
  v_lshrrev_b32 v23, 5, v0
  s_lshl_b32 s58, s57, 1
  v_add_u32 v23, s58, v23
  v_mul_u32_u24 v3, 288, v23
  v_and_b32 v23, 7, v0
  v_lshl_add_u32 v3, v23, 5, v3
  v_bfe_u32 v23, v0, 4, 1
  v_lshl_add_u32 v3, v23, 4, v3
  v_and_b32 v23, 1, v0
  v_cmp_eq_u32 vcc, 1, v23
  v_mov_b32 v24, 0xffff
  v_mov_b32 v25, 0xffff0000
  v_cndmask_b32 v24, v24, v25, vcc
  v_bfe_u32 v23, v0, 1, 2
  v_cmp_eq_u32 vcc, 0, v23
  s_nop 1
  v_cndmask_b32 v4, 0, v24, vcc
  v_cmp_eq_u32 vcc, 1, v23
  s_nop 1
  v_cndmask_b32 v5, 0, v24, vcc
  v_cmp_eq_u32 vcc, 2, v23
  s_nop 1
  v_cndmask_b32 v6, 0, v24, vcc
  v_cmp_eq_u32 vcc, 3, v23
  s_nop 1
  v_cndmask_b32 v7, 0, v24, vcc
  s_mov_b32 s94, 0xffff0000
  s_mov_b32 s62, 0x0f0f0f0f
  s_mov_b32 s63, 0x0f0f0f0f
  s_mov_b32 s64, 0xf0f0f0f0
  s_mov_b32 s65, 0xf0f0f0f0
  s_mov_b32 s66, -1
  s_mov_b32 s67, 0xf
  s_mul_i32 s58, s57, 288
  v_lshlrev_b32 v21, 3, v0
  v_add_u32 v21, s58, v21
  v_lshlrev_b32 v18, 1, v21
  s_lshr_b32 s68, s99, 4
  s_and_b32 s69, s99, 15
  s_cmp_lt_u32 s2, 144
  s_cbranch_scc1 L_H_OTHER
  s_cmp_lt_u32 s2, 208
  s_cbranch_scc1 L_H_Q
  s_cmp_lt_u32 s2, 226
  s_cbranch_scc1 L_H_MODA
L_H_OTHER:
  s_waitcnt lgkmcnt(0)
  buffer_load_dword v20, v9, s[16:19], 0 offen sc1
  s_barrier
  s_waitcnt vmcnt(0)
  v_readfirstlane_b32 s56, v20
  s_nop 3
  s_mul_i32 s56, s56, 1664525
  s_add_u32 s56, s56, 1013904223
  s_branch L_X1
L_H_MODA:
  s_sub_u32 s60, s2, 208
  v_lshrrev_b32 v8, 3, v0
  v_mul_u32_u24 v8, 6912, v8
  v_and_b32 v22, 7, v0
  v_lshl_add_u32 v8, v22, 4, v8
  s_mul_i32 s59, s57, 995328
  s_lshl_b32 s58, s60, 7
  s_add_u32 s59, s59, s58
  s_waitcnt lgkmcnt(0)
  buffer_load_dword v20, v9, s[16:19], 0 offen sc1
  s_mov_b64 exec, s[66:67]
  buffer_load_dwordx2 v[24:25], v21, s[48:51], 0 offen
  s_mov_b64 exec, -1
  s_mov_b32 s61, s59
  buffer_load_dwordx4 v[56:59], v8, s[40:43], s61 offen nt
  s_add_u32 s61, s61, 55296
  buffer_load_dwordx4 v[60:63], v8, s[40:43], s61 offen nt
  s_add_u32 s61, s61, 55296
  buffer_load_dwordx4 v[64:67], v8, s[40:43], s61 offen nt
  s_add_u32 s61, s61, 55296
  buffer_load_dwordx4 v[68:71], v8, s[40:43], s61 offen nt
  s_add_u32 s61, s61, 55296
  buffer_load_dwordx4 v[72:75], v8, s[40:43], s61 offen nt
  s_add_u32 s61, s61, 55296
  buffer_load_dwordx4 v[76:79], v8, s[40:43], s61 offen nt
  s_add_u32 s61, s61, 55296
  buffer_load_dwordx4 v[80:83], v8, s[40:43], s61 offen nt
  s_add_u32 s61, s61, 55296
  buffer_load_dwordx4 v[84:87], v8, s[40:43], s61 offen nt
  s_add_u32 s61, s61, 55296
  buffer_load_dwordx4 v[88:91], v8, s[40:43], s61 offen nt
  s_add_u32 s61, s61, 55296
  buffer_load_dwordx4 v[92:95], v8, s[40:43], s61 offen nt
  s_add_u32 s61, s61, 55296
  buffer_load_dwordx4 v[96:99], v8, s[40:43], s61 offen nt
  s_add_u32 s61, s61, 55296
  buffer_load_dwordx4 v[100:103], v8, s[40:43], s61 offen nt
  s_add_u32 s61, s61, 55296
  buffer_load_dwordx4 v[104:107], v8, s[40:43], s61 offen nt
  s_add_u32 s61, s61, 55296
  buffer_load_dwordx4 v[108:111], v8, s[40:43], s61 offen nt
  s_add_u32 s61, s61, 55296
  buffer_load_dwordx4 v[112:115], v8, s[40:43], s61 offen nt
  s_add_u32 s61, s61, 55296
  buffer_load_dwordx4 v[116:119], v8, s[40:43], s61 offen nt
  s_add_u32 s61, s61, 55296
  buffer_load_dwordx4 v[120:123], v8, s[40:43], s61 offen nt
  s_add_u32 s61, s61, 55296
  buffer_load_dwordx4 v[124:127], v8, s[40:43], s61 offen nt
  s_barrier
  s_waitcnt vmcnt(18)
  v_readfirstlane_b32 s56, v20
  s_nop 3
  s_mul_i32 s56, s56, 1664525
  s_add_u32 s56, s56, 1013904223
  s_mov_b64 exec, s[66:67]
  v_and_b32 v29, s94, v24
  v_and_b32 v31, s94, v25
  v_lshlrev_b32 v28, 16, v24
  v_lshlrev_b32 v30, 16, v25
  v_mul_f32 v32, 0xbfb8aa00, v28
  v_mul_f32 v33, 0xbfb8aa00, v29
  v_mul_f32 v34, 0xbfb8aa00, v30
  v_mul_f32 v35, 0xbfb8aa00, v31
  v_mul_f32 v36, 0xb6a407db, v28
  v_mul_f32 v37, 0xb6a407db, v29
  v_mul_f32 v38, 0xb6a407db, v30
  v_mul_f32 v39, 0xb6a407db, v31
  v_min_f32 v32, 0x42fc0000, v32
  v_min_f32 v33, 0x42fc0000, v33
  v_min_f32 v34, 0x42fc0000, v34
  v_min_f32 v35, 0x42fc0000, v35
  v_exp_f32 v32, v32
  v_exp_f32 v33, v33
  v_exp_f32 v34, v34
  v_exp_f32 v35, v35
  v_fmac_f32 v32, v32, v36
  v_fmac_f32 v33, v33, v37
  v_fmac_f32 v34, v34, v38
  v_fmac_f32 v35, v35, v39
  v_add_f32 v32, 1.0, v32
  v_add_f32 v33, 1.0, v33
  v_add_f32 v34, 1.0, v34
  v_add_f32 v35, 1.0, v35
  v_rcp_f32 v36, v32
  v_rcp_f32 v37, v33
  v_rcp_f32 v38, v34
  v_rcp_f32 v39, v35
  v_mul_f32 v40, v28, v36
  v_mul_f32 v41, v29, v37
  v_mul_f32 v42, v30, v38
  v_mul_f32 v43, v31, v39
  v_fma_f32 v32, -v40, v32, v28
  v_fma_f32 v33, -v41, v33, v29
  v_fma_f32 v34, -v42, v34, v30
  v_fma_f32 v35, -v43, v35, v31
  v_fma_f32 v28, v32, v36, v40
  v_fma_f32 v29, v33, v37, v41
  v_fma_f32 v30, v34, v38, v42
  v_fma_f32 v31, v35, v39, v43
  v_cvt_pk_bf16_f32 v28, v28, v28
  v_cvt_pk_bf16_f32 v29, v29, v29
  v_cvt_pk_bf16_f32 v30, v30, v30
  v_cvt_pk_bf16_f32 v31, v31, v31
  ds_write_b32 v2, v28 offset:0
  ds_write_b32 v2, v29 offset:80
  ds_write_b32 v2, v30 offset:160
  ds_write_b32 v2, v31 offset:240
  s_mov_b64 exec, -1
  ds_read_b128 v[26:29], v1 offset:0
  ds_read_b128 v[30:33], v1 offset:16
  ds_read_b128 v[34:37], v1 offset:32
  ds_read_b128 v[38:41], v1 offset:48
  ds_read_b64 v[42:43], v1 offset:64
  s_waitcnt vmcnt(0)
  s_waitcnt lgkmcnt(0)
  v_and_b32 v44, v26, v4
  v_and_b32 v45, v26, v5
  v_and_b32 v46, v26, v6
  v_and_b32 v47, v26, v7
  s_nop 1
  v_mfma_f32_16x16x32_bf16 v[52:55], v[44:47], v[56:59], 0
  v_and_b32 v48, v27, v4
  v_and_b32 v49, v27, v5
  v_and_b32 v50, v27, v6
  v_and_b32 v51, v27, v7
  s_nop 1
  v_mfma_f32_16x16x32_bf16 v[52:55], v[48:51], v[60:63], v[52:55]
  v_and_b32 v44, v28, v4
  v_and_b32 v45, v28, v5
  v_and_b32 v46, v28, v6
  v_and_b32 v47, v28, v7
  s_nop 1
  v_mfma_f32_16x16x32_bf16 v[52:55], v[44:47], v[64:67], v[52:55]
  v_and_b32 v48, v29, v4
  v_and_b32 v49, v29, v5
  v_and_b32 v50, v29, v6
  v_and_b32 v51, v29, v7
  s_nop 1
  v_mfma_f32_16x16x32_bf16 v[52:55], v[48:51], v[68:71], v[52:55]
  v_and_b32 v44, v30, v4
  v_and_b32 v45, v30, v5
  v_and_b32 v46, v30, v6
  v_and_b32 v47, v30, v7
  s_nop 1
  v_mfma_f32_16x16x32_bf16 v[52:55], v[44:47], v[72:75], v[52:55]
  v_and_b32 v48, v31, v4
  v_and_b32 v49, v31, v5
  v_and_b32 v50, v31, v6
  v_and_b32 v51, v31, v7
  s_nop 1
  v_mfma_f32_16x16x32_bf16 v[52:55], v[48:51], v[76:79], v[52:55]
  v_and_b32 v44, v32, v4
  v_and_b32 v45, v32, v5
  v_and_b32 v46, v32, v6
  v_and_b32 v47, v32, v7
  s_nop 1
  v_mfma_f32_16x16x32_bf16 v[52:55], v[44:47], v[80:83], v[52:55]
  v_and_b32 v48, v33, v4
  v_and_b32 v49, v33, v5
  v_and_b32 v50, v33, v6
  v_and_b32 v51, v33, v7
  s_nop 1
  v_mfma_f32_16x16x32_bf16 v[52:55], v[48:51], v[84:87], v[52:55]
  v_and_b32 v44, v34, v4
  v_and_b32 v45, v34, v5
  v_and_b32 v46, v34, v6
  v_and_b32 v47, v34, v7
  s_nop 1
  v_mfma_f32_16x16x32_bf16 v[52:55], v[44:47], v[88:91], v[52:55]
  v_and_b32 v48, v35, v4
  v_and_b32 v49, v35, v5
  v_and_b32 v50, v35, v6
  v_and_b32 v51, v35, v7
  s_nop 1
  v_mfma_f32_16x16x32_bf16 v[52:55], v[48:51], v[92:95], v[52:55]
  v_and_b32 v44, v36, v4
  v_and_b32 v45, v36, v5
  v_and_b32 v46, v36, v6
  v_and_b32 v47, v36, v7
  s_nop 1
  v_mfma_f32_16x16x32_bf16 v[52:55], v[44:47], v[96:99], v[52:55]
  v_and_b32 v48, v37, v4
  v_and_b32 v49, v37, v5
  v_and_b32 v50, v37, v6
  v_and_b32 v51, v37, v7
  s_nop 1
  v_mfma_f32_16x16x32_bf16 v[52:55], v[48:51], v[100:103], v[52:55]
  v_and_b32 v44, v38, v4
  v_and_b32 v45, v38, v5
  v_and_b32 v46, v38, v6
  v_and_b32 v47, v38, v7
  s_nop 1
  v_mfma_f32_16x16x32_bf16 v[52:55], v[44:47], v[104:107], v[52:55]
  v_and_b32 v48, v39, v4
  v_and_b32 v49, v39, v5
  v_and_b32 v50, v39, v6
  v_and_b32 v51, v39, v7
  s_nop 1
  v_mfma_f32_16x16x32_bf16 v[52:55], v[48:51], v[108:111], v[52:55]
  v_and_b32 v44, v40, v4
  v_and_b32 v45, v40, v5
  v_and_b32 v46, v40, v6
  v_and_b32 v47, v40, v7
  s_nop 1
  v_mfma_f32_16x16x32_bf16 v[52:55], v[44:47], v[112:115], v[52:55]
  v_and_b32 v48, v41, v4
  v_and_b32 v49, v41, v5
  v_and_b32 v50, v41, v6
  v_and_b32 v51, v41, v7
  s_nop 1
  v_mfma_f32_16x16x32_bf16 v[52:55], v[48:51], v[116:119], v[52:55]
  v_and_b32 v44, v42, v4
  v_and_b32 v45, v42, v5
  v_and_b32 v46, v42, v6
  v_and_b32 v47, v42, v7
  s_nop 1
  v_mfma_f32_16x16x32_bf16 v[52:55], v[44:47], v[120:123], v[52:55]
  v_and_b32 v48, v43, v4
  v_and_b32 v49, v43, v5
  v_and_b32 v50, v43, v6
  v_and_b32 v51, v43, v7
  s_nop 1
  v_mfma_f32_16x16x32_bf16 v[52:55], v[48:51], v[124:127], v[52:55]
  s_nop 7
  s_mov_b32 exec_lo, 0x00ff00ff
  s_mov_b32 exec_hi, 0xff00ff00
  ds_write_b128 v3, v[52:55] offset:12800
  s_mov_b64 exec, -1
  s_mov_b64 exec, 1
  v_mov_b32 v22, 1
  s_waitcnt lgkmcnt(0)
  ds_add_rtn_u32 v23, v9, v22 offset:16
  s_waitcnt lgkmcnt(0)
  v_readfirstlane_b32 s91, v23
  s_mov_b64 exec, -1
  s_nop 2
  s_cmp_eq_u32 s91, 3
  s_cbranch_scc0 MODSKIP_75
  s_mov_b64 exec, 0xffff
  v_lshlrev_b32 v22, 4, v0
  ds_read_b128 v[24:27], v22 offset:12800
  ds_read_b128 v[28:31], v22 offset:13088
  ds_read_b128 v[32:35], v22 offset:13376
  ds_read_b128 v[36:39], v22 offset:13664
  ds_read_b128 v[40:43], v22 offset:13952
  ds_read_b128 v[44:47], v22 offset:14240
  ds_read_b128 v[48:51], v22 offset:14528
  ds_read_b128 v[52:55], v22 offset:14816
  s_waitcnt lgkmcnt(0)
  v_add_f32 v24, v24, v40
  v_add_f32 v25, v25, v41
  v_add_f32 v26, v26, v42
  v_add_f32 v27, v27, v43
  v_add_f32 v28, v28, v44
  v_add_f32 v29, v29, v45
  v_add_f32 v30, v30, v46
  v_add_f32 v31, v31, v47
  v_add_f32 v32, v32, v48
  v_add_f32 v33, v33, v49
  v_add_f32 v34, v34, v50
  v_add_f32 v35, v35, v51
  v_add_f32 v36, v36, v52
  v_add_f32 v37, v37, v53
  v_add_f32 v38, v38, v54
  v_add_f32 v39, v39, v55
  v_add_f32 v24, v24, v32
  v_add_f32 v25, v25, v33
  v_add_f32 v26, v26, v34
  v_add_f32 v27, v27, v35
  v_add_f32 v28, v28, v36
  v_add_f32 v29, v29, v37
  v_add_f32 v30, v30, v38
  v_add_f32 v31, v31, v39
  v_add_f32 v24, v24, v28
  v_add_f32 v25, v25, v29
  v_add_f32 v26, v26, v30
  v_add_f32 v27, v27, v31
  s_lshl_b32 s58, s60, 8
  s_add_u32 s58, s58, 4096
  v_cvt_pk_bf16_f32 v24, v24, v25
  v_cvt_pk_bf16_f32 v26, v26, v27
  v_mov_b32 v25, s56
  v_mov_b32 v27, s56
  buffer_store_dwordx4 v[24:27], v22, s[16:19], s58 offen sc1
  s_mov_b64 exec, -1
MODSKIP_75:
  s_branch L_X1
L_H_Q:
  s_sub_u32 s60, s2, 144
  v_lshrrev_b32 v8, 3, v0
  v_mul_u32_u24 v8, 8192, v8
  v_and_b32 v22, 7, v0
  v_lshl_add_u32 v8, v22, 4, v8
  s_mul_i32 s59, s57, 1179648
  s_lshl_b32 s58, s60, 7
  s_add_u32 s59, s59, s58
  v_lshlrev_b32 v22, 1, v0
  s_waitcnt lgkmcnt(0)
  buffer_load_dword v20, v9, s[16:19], 0 offen sc1
  s_mov_b64 exec, s[66:67]
  buffer_load_dwordx2 v[24:25], v21, s[44:47], 0 offen
  s_mov_b64 exec, -1
  buffer_load_ushort v28, v22, s[44:47], 0 offen offset:0
  buffer_load_ushort v29, v22, s[44:47], 0 offen offset:128
  buffer_load_ushort v30, v22, s[44:47], 0 offen offset:256
  buffer_load_ushort v31, v22, s[44:47], 0 offen offset:384
  buffer_load_ushort v32, v22, s[44:47], 0 offen offset:512
  buffer_load_ushort v33, v22, s[44:47], 0 offen offset:640
  buffer_load_ushort v34, v22, s[44:47], 0 offen offset:768
  buffer_load_ushort v35, v22, s[44:47], 0 offen offset:896
  buffer_load_ushort v36, v22, s[44:47], 0 offen offset:1024
  s_mov_b32 s61, s59
  buffer_load_dwordx4 v[56:59], v8, s[20:23], s61 offen nt
  s_add_u32 s61, s61, 65536
  buffer_load_dwordx4 v[60:63], v8, s[20:23], s61 offen nt
  s_add_u32 s61, s61, 65536
  buffer_load_dwordx4 v[64:67], v8, s[20:23], s61 offen nt
  s_add_u32 s61, s61, 65536
  buffer_load_dwordx4 v[68:71], v8, s[20:23], s61 offen nt
  s_add_u32 s61, s61, 65536
  buffer_load_dwordx4 v[72:75], v8, s[20:23], s61 offen nt
  s_add_u32 s61, s61, 65536
  buffer_load_dwordx4 v[76:79], v8, s[20:23], s61 offen nt
  s_add_u32 s61, s61, 65536
  buffer_load_dwordx4 v[80:83], v8, s[20:23], s61 offen nt
  s_add_u32 s61, s61, 65536
  buffer_load_dwordx4 v[84:87], v8, s[20:23], s61 offen nt
  s_add_u32 s61, s61, 65536
  buffer_load_dwordx4 v[88:91], v8, s[20:23], s61 offen nt
  s_add_u32 s61, s61, 65536
  buffer_load_dwordx4 v[92:95], v8, s[20:23], s61 offen nt
  s_add_u32 s61, s61, 65536
  buffer_load_dwordx4 v[96:99], v8, s[20:23], s61 offen nt
  s_add_u32 s61, s61, 65536
  buffer_load_dwordx4 v[100:103], v8, s[20:23], s61 offen nt
  s_add_u32 s61, s61, 65536
  buffer_load_dwordx4 v[104:107], v8, s[20:23], s61 offen nt
  s_add_u32 s61, s61, 65536
  buffer_load_dwordx4 v[108:111], v8, s[20:23], s61 offen nt
  s_add_u32 s61, s61, 65536
  buffer_load_dwordx4 v[112:115], v8, s[20:23], s61 offen nt
  s_add_u32 s61, s61, 65536
  buffer_load_dwordx4 v[116:119], v8, s[20:23], s61 offen nt
  s_add_u32 s61, s61, 65536
  buffer_load_dwordx4 v[120:123], v8, s[20:23], s61 offen nt
  s_add_u32 s61, s61, 65536
  buffer_load_dwordx4 v[124:127], v8, s[20:23], s61 offen nt
  s_barrier
  s_waitcnt vmcnt(18)
  v_readfirstlane_b32 s56, v20
  s_nop 3
  s_mul_i32 s56, s56, 1664525
  s_add_u32 s56, s56, 1013904223
  v_lshlrev_b32 v28, 16, v28
  v_lshlrev_b32 v29, 16, v29
  v_lshlrev_b32 v30, 16, v30
  v_lshlrev_b32 v31, 16, v31
  v_lshlrev_b32 v32, 16, v32
  v_lshlrev_b32 v33, 16, v33
  v_lshlrev_b32 v34, 16, v34
  v_lshlrev_b32 v35, 16, v35
  v_lshlrev_b32 v36, 16, v36
  v_add_f32 v22, v28, v29
  v_add_f32 v22, v22, v30
  v_add_f32 v22, v22, v31
  v_add_f32 v22, v22, v32
  v_add_f32 v22, v22, v33
  v_add_f32 v22, v22, v34
  v_add_f32 v22, v22, v35
  v_add_f32 v22, v22, v36
  s_nop 1
  v_add_f32_dpp v22, v22, v22 quad_perm:[1,0,3,2] row_mask:0xf bank_mask:0xf
  s_nop 1
  v_add_f32_dpp v22, v22, v22 quad_perm:[2,3,0,1] row_mask:0xf bank_mask:0xf
  s_nop 1
  v_add_f32_dpp v22, v22, v22 row_half_mirror row_mask:0xf bank_mask:0xf
  s_nop 1
  v_add_f32_dpp v22, v22, v22 row_mirror row_mask:0xf bank_mask:0xf
  v_mov_b32 v23, v22
  s_nop 1
  v_permlane16_swap_b32 v22, v23
  v_add_f32 v22, v22, v23
  v_mov_b32 v23, v22
  s_nop 1
  v_permlane32_swap_b32 v22, v23
  v_add_f32 v22, v22, v23
  v_mul_f32 v22, 0x3ae38e39, v22
  v_sub_f32 v28, v28, v22
  v_sub_f32 v29, v29, v22
  v_sub_f32 v30, v30, v22
  v_sub_f32 v31, v31, v22
  v_sub_f32 v32, v32, v22
  v_sub_f32 v33, v33, v22
  v_sub_f32 v34, v34, v22
  v_sub_f32 v35, v35, v22
  v_sub_f32 v36, v36, v22
  v_mul_f32 v23, v28, v28
  v_fmac_f32 v23, v29, v29
  v_fmac_f32 v23, v30, v30
  v_fmac_f32 v23, v31, v31
  v_fmac_f32 v23, v32, v32
  v_fmac_f32 v23, v33, v33
  v_fmac_f32 v23, v34, v34
  v_fmac_f32 v23, v35, v35
  v_fmac_f32 v23, v36, v36
  s_nop 1
  v_add_f32_dpp v23, v23, v23 quad_perm:[1,0,3,2] row_mask:0xf bank_mask:0xf
  s_nop 1
  v_add_f32_dpp v23, v23, v23 quad_perm:[2,3,0,1] row_mask:0xf bank_mask:0xf
  s_nop 1
  v_add_f32_dpp v23, v23, v23 row_half_mirror row_mask:0xf bank_mask:0xf
  s_nop 1
  v_add_f32_dpp v23, v23, v23 row_mirror row_mask:0xf bank_mask:0xf
  v_mov_b32 v28, v23
  s_nop 1
  v_permlane16_swap_b32 v23, v28
  v_add_f32 v23, v23, v28
  v_mov_b32 v28, v23
  s_nop 1
  v_permlane32_swap_b32 v23, v28
  v_add_f32 v23, v23, v28
  v_mul_f32 v23, 0x3ae38e39, v23
  v_cvt_pk_bf16_f32 v22, 0, v22
  v_cvt_pk_bf16_f32 v23, 0, v23
  v_add_f32 v23, 0x3727c5ac, v23
  v_cvt_pk_bf16_f32 v23, 0, v23
  v_sqrt_f32 v23, v23
  s_nop 0
  v_cvt_pk_bf16_f32 v23, 0, v23
  v_rcp_f32 v23, v23
  v_readfirstlane_b32 s92, v22
  v_readfirstlane_b32 s93, v23
  v_and_b32 v11, s94, v24
  v_and_b32 v13, s94, v25
  v_lshlrev_b32 v10, 16, v24
  v_lshlrev_b32 v12, 16, v25
  v_subrev_f32 v10, s92, v10
  v_subrev_f32 v11, s92, v11
  v_subrev_f32 v12, s92, v12
  v_subrev_f32 v13, s92, v13
  v_cvt_pk_bf16_f32 v10, 0, v10
  v_cvt_pk_bf16_f32 v11, 0, v11
  v_cvt_pk_bf16_f32 v12, 0, v12
  v_cvt_pk_bf16_f32 v13, 0, v13
  v_mul_f32 v10, s93, v10
  v_mul_f32 v11, s93, v11
  v_mul_f32 v12, s93, v12
  v_mul_f32 v13, s93, v13
  v_cvt_pk_bf16_f32 v10, 0, v10
  v_cvt_pk_bf16_f32 v11, 0, v11
  v_cvt_pk_bf16_f32 v12, 0, v12
  v_cvt_pk_bf16_f32 v13, 0, v13
  s_mov_b64 exec, s[66:67]
  s_mov_b32 s58, 4096
  s_mov_b32 s90, 4000
PL_76:
  buffer_load_dwordx4 v[24:27], v18, s[16:19], s58 offen offset:0 sc1
  buffer_load_dwordx4 v[28:31], v18, s[16:19], s58 offen offset:2304 sc1
  s_waitcnt vmcnt(0)
  v_xor_b32 v32, s56, v25
  v_xor_b32 v23, s56, v27
  v_or_b32 v32, v32, v23
  v_xor_b32 v23, s56, v29
  v_or_b32 v32, v32, v23
  v_xor_b32 v23, s56, v31
  v_or_b32 v32, v32, v23
  v_cmp_eq_u32 vcc, 0, v32
  s_nop 3
  s_cmp_eq_u64 vcc, s[66:67]
  s_cbranch_scc1 PLO_77
  s_sleep 2
  s_sub_u32 s90, s90, 1
  s_cbranch_scc0 PL_76
  s_or_b32 s95, s95, 16
PLO_77:
  v_and_b32 v33, s94, v24
  v_and_b32 v35, s94, v26
  v_lshlrev_b32 v32, 16, v24
  v_lshlrev_b32 v34, 16, v26
  v_and_b32 v37, s94, v28
  v_and_b32 v39, s94, v30
  v_lshlrev_b32 v36, 16, v28
  v_lshlrev_b32 v38, 16, v30
  v_add_f32 v36, 1.0, v36
  v_add_f32 v37, 1.0, v37
  v_add_f32 v38, 1.0, v38
  v_add_f32 v39, 1.0, v39
  v_cvt_pk_bf16_f32 v36, 0, v36
  v_cvt_pk_bf16_f32 v37, 0, v37
  v_cvt_pk_bf16_f32 v38, 0, v38
  v_cvt_pk_bf16_f32 v39, 0, v39
  v_mul_f32 v36, v36, v10
  v_mul_f32 v37, v37, v11
  v_mul_f32 v38, v38, v12
  v_mul_f32 v39, v39, v13
  v_cvt_pk_bf16_f32 v36, 0, v36
  v_cvt_pk_bf16_f32 v37, 0, v37
  v_cvt_pk_bf16_f32 v38, 0, v38
  v_cvt_pk_bf16_f32 v39, 0, v39
  v_add_f32 v36, v36, v32
  v_add_f32 v37, v37, v33
  v_add_f32 v38, v38, v34
  v_add_f32 v39, v39, v35
  v_cvt_pk_bf16_f32 v36, v36, v36
  v_cvt_pk_bf16_f32 v37, v37, v37
  v_cvt_pk_bf16_f32 v38, v38, v38
  v_cvt_pk_bf16_f32 v39, v39, v39
  ds_write_b32 v2, v36 offset:0
  ds_write_b32 v2, v37 offset:80
  ds_write_b32 v2, v38 offset:160
  ds_write_b32 v2, v39 offset:240
  s_mov_b64 exec, -1
  ds_read_b128 v[26:29], v1 offset:0
  ds_read_b128 v[30:33], v1 offset:16
  ds_read_b128 v[34:37], v1 offset:32
  ds_read_b128 v[38:41], v1 offset:48
  ds_read_b64 v[42:43], v1 offset:64
  s_waitcnt lgkmcnt(0)
  v_and_b32 v44, v26, v4
  v_and_b32 v45, v26, v5
  v_and_b32 v46, v26, v6
  v_and_b32 v47, v26, v7
  s_nop 1
  v_mfma_f32_16x16x32_bf16 v[52:55], v[44:47], v[56:59], 0
  v_and_b32 v48, v27, v4
  v_and_b32 v49, v27, v5
  v_and_b32 v50, v27, v6
  v_and_b32 v51, v27, v7
  s_nop 1
  v_mfma_f32_16x16x32_bf16 v[52:55], v[48:51], v[60:63], v[52:55]
  v_and_b32 v44, v28, v4
  v_and_b32 v45, v28, v5
  v_and_b32 v46, v28, v6
  v_and_b32 v47, v28, v7
  s_nop 1
  v_mfma_f32_16x16x32_bf16 v[52:55], v[44:47], v[64:67], v[52:55]
  v_and_b32 v48, v29, v4
  v_and_b32 v49, v29, v5
  v_and_b32 v50, v29, v6
  v_and_b32 v51, v29, v7
  s_nop 1
  v_mfma_f32_16x16x32_bf16 v[52:55], v[48:51], v[68:71], v[52:55]
  v_and_b32 v44, v30, v4
  v_and_b32 v45, v30, v5
  v_and_b32 v46, v30, v6
  v_and_b32 v47, v30, v7
  s_nop 1
  v_mfma_f32_16x16x32_bf16 v[52:55], v[44:47], v[72:75], v[52:55]
  v_and_b32 v48, v31, v4
  v_and_b32 v49, v31, v5
  v_and_b32 v50, v31, v6
  v_and_b32 v51, v31, v7
  s_nop 1
  v_mfma_f32_16x16x32_bf16 v[52:55], v[48:51], v[76:79], v[52:55]
  v_and_b32 v44, v32, v4
  v_and_b32 v45, v32, v5
  v_and_b32 v46, v32, v6
  v_and_b32 v47, v32, v7
  s_nop 1
  v_mfma_f32_16x16x32_bf16 v[52:55], v[44:47], v[80:83], v[52:55]
  v_and_b32 v48, v33, v4
  v_and_b32 v49, v33, v5
  v_and_b32 v50, v33, v6
  v_and_b32 v51, v33, v7
  s_nop 1
  v_mfma_f32_16x16x32_bf16 v[52:55], v[48:51], v[84:87], v[52:55]
  v_and_b32 v44, v34, v4
  v_and_b32 v45, v34, v5
  v_and_b32 v46, v34, v6
  v_and_b32 v47, v34, v7
  s_nop 1
  v_mfma_f32_16x16x32_bf16 v[52:55], v[44:47], v[88:91], v[52:55]
  v_and_b32 v48, v35, v4
  v_and_b32 v49, v35, v5
  v_and_b32 v50, v35, v6
  v_and_b32 v51, v35, v7
  s_nop 1
  v_mfma_f32_16x16x32_bf16 v[52:55], v[48:51], v[92:95], v[52:55]
  v_and_b32 v44, v36, v4
  v_and_b32 v45, v36, v5
  v_and_b32 v46, v36, v6
  v_and_b32 v47, v36, v7
  s_nop 1
  v_mfma_f32_16x16x32_bf16 v[52:55], v[44:47], v[96:99], v[52:55]
  v_and_b32 v48, v37, v4
  v_and_b32 v49, v37, v5
  v_and_b32 v50, v37, v6
  v_and_b32 v51, v37, v7
  s_nop 1
  v_mfma_f32_16x16x32_bf16 v[52:55], v[48:51], v[100:103], v[52:55]
  v_and_b32 v44, v38, v4
  v_and_b32 v45, v38, v5
  v_and_b32 v46, v38, v6
  v_and_b32 v47, v38, v7
  s_nop 1
  v_mfma_f32_16x16x32_bf16 v[52:55], v[44:47], v[104:107], v[52:55]
  v_and_b32 v48, v39, v4
  v_and_b32 v49, v39, v5
  v_and_b32 v50, v39, v6
  v_and_b32 v51, v39, v7
  s_nop 1
  v_mfma_f32_16x16x32_bf16 v[52:55], v[48:51], v[108:111], v[52:55]
  v_and_b32 v44, v40, v4
  v_and_b32 v45, v40, v5
  v_and_b32 v46, v40, v6
  v_and_b32 v47, v40, v7
  s_nop 1
  v_mfma_f32_16x16x32_bf16 v[52:55], v[44:47], v[112:115], v[52:55]
  v_and_b32 v48, v41, v4
  v_and_b32 v49, v41, v5
  v_and_b32 v50, v41, v6
  v_and_b32 v51, v41, v7
  s_nop 1
  v_mfma_f32_16x16x32_bf16 v[52:55], v[48:51], v[116:119], v[52:55]
  v_and_b32 v44, v42, v4
  v_and_b32 v45, v42, v5
  v_and_b32 v46, v42, v6
  v_and_b32 v47, v42, v7
  s_nop 1
  v_mfma_f32_16x16x32_bf16 v[52:55], v[44:47], v[120:123], v[52:55]
  v_and_b32 v48, v43, v4
  v_and_b32 v49, v43, v5
  v_and_b32 v50, v43, v6
  v_and_b32 v51, v43, v7
  s_nop 1
  v_mfma_f32_16x16x32_bf16 v[52:55], v[48:51], v[124:127], v[52:55]
  s_mov_b32 exec_lo, 0x00ff00ff
  s_mov_b32 exec_hi, 0xff00ff00
  s_nop 5
  ds_write_b128 v3, v[52:55] offset:12800
  s_mov_b64 exec, -1
  s_mov_b64 exec, 1
  v_mov_b32 v22, 1
  s_waitcnt lgkmcnt(0)
  ds_add_rtn_u32 v23, v9, v22 offset:16
  s_waitcnt lgkmcnt(0)
  v_readfirstlane_b32 s91, v23
  s_mov_b64 exec, -1
  s_nop 2
  s_cmp_eq_u32 s91, 3
  s_cbranch_scc0 QSKIP_78
  s_mov_b64 exec, 0xffff
  v_lshlrev_b32 v22, 4, v0
  ds_read_b128 v[24:27], v22 offset:12800
  ds_read_b128 v[28:31], v22 offset:13088
  ds_read_b128 v[32:35], v22 offset:13376
  ds_read_b128 v[36:39], v22 offset:13664
  ds_read_b128 v[40:43], v22 offset:13952
  ds_read_b128 v[44:47], v22 offset:14240
  ds_read_b128 v[48:51], v22 offset:14528
  ds_read_b128 v[52:55], v22 offset:14816
  s_waitcnt lgkmcnt(0)
  v_add_f32 v24, v24, v40
  v_add_f32 v25, v25, v41
  v_add_f32 v26, v26, v42
  v_add_f32 v27, v27, v43
  v_add_f32 v28, v28, v44
  v_add_f32 v29, v29, v45
  v_add_f32 v30, v30, v46
  v_add_f32 v31, v31, v47
  v_add_f32 v32, v32, v48
  v_add_f32 v33, v33, v49
  v_add_f32 v34, v34, v50
  v_add_f32 v35, v35, v51
  v_add_f32 v36, v36, v52
  v_add_f32 v37, v37, v53
  v_add_f32 v38, v38, v54
  v_add_f32 v39, v39, v55
  v_add_f32 v24, v24, v32
  v_add_f32 v25, v25, v33
  v_add_f32 v26, v26, v34
  v_add_f32 v27, v27, v35
  v_add_f32 v28, v28, v36
  v_add_f32 v29, v29, v37
  v_add_f32 v30, v30, v38
  v_add_f32 v31, v31, v39
  v_add_f32 v24, v24, v28
  v_add_f32 v25, v25, v29
  v_add_f32 v26, v26, v30
  v_add_f32 v27, v27, v31
  s_lshl_b32 s58, s60, 8
  s_add_u32 s58, s58, 32768
  v_cvt_pk_bf16_f32 v24, v24, v25
  v_cvt_pk_bf16_f32 v26, v26, v27
  v_mov_b32 v25, s56
  v_mov_b32 v27, s56
  buffer_store_dwordx4 v[24:27], v22, s[16:19], s58 offen sc1
  s_mov_b64 exec, -1
QSKIP_78:
L_X1:
  s_mov_b32 s75, 0
  s_cmp_lg_u32 s57, 0
  s_cbranch_scc1 L_D
  s_mov_b32 s75, 1
  s_cmp_lt_u32 s2, 144
  s_cbranch_scc1 L_D
  s_sub_u32 s58, s2, 220
  s_cmp_lt_u32 s58, 36
  s_cbranch_scc1 L_D
  s_mov_b32 s75, 0
L_X1B:
  s_lshl_b32 s58, s68, 10
  s_add_u32 s58, s58, 32768
  v_lshlrev_b32 v22, 4, v0
  s_mov_b32 s90, 4000
PL_79:
  buffer_load_dwordx4 v[24:27], v22, s[16:19], s58 offen offset:0 sc1
  s_waitcnt vmcnt(0)
  v_xor_b32 v28, s56, v25
  v_xor_b32 v23, s56, v27
  v_or_b32 v28, v28, v23
  v_cmp_eq_u32 vcc, 0, v28
  s_nop 3
  s_cmp_eq_u64 vcc, -1
  s_cbranch_scc1 PLO_80
  s_sleep 4
  s_sub_u32 s90, s90, 1
  s_cbranch_scc0 PL_79
  s_or_b32 s95, s95, 8
PLO_80:
  v_mov_b32 v25, v26
  v_lshlrev_b32 v23, 3, v0
  ds_write_b64 v23, v[24:25] offset:256
  v_mov_b32 v23, 1
  s_waitcnt lgkmcnt(0)
  ds_write_b32 v9, v23 offset:0
  v_mov_b32 v24, 0
  v_mov_b32 v25, 0
  v_mov_b32 v26, 0
  v_mov_b32 v27, 0
  s_lshl_b32 s58, s99, 10
  s_add_u32 s58, s58, 65536
  buffer_store_dwordx4 v[24:27], v22, s[16:19], s58 offen sc1
  s_cmp_lt_u32 s2, 144
  s_cbranch_scc0 L_Z_NOTMLP
  s_mul_i32 s58, s2, 2304
  s_add_u32 s58, s58, 393216
  buffer_store_dwordx4 v[24:27], v22, s[16:19], s58 offen sc1
  buffer_store_dwordx4 v[24:27], v22, s[16:19], s58 offen offset:1024 sc1
  s_mov_b64 exec, 0xffff
  buffer_store_dwordx4 v[24:27], v22, s[16:19], s58 offen offset:2048 sc1
  s_mov_b64 exec, -1
  s_branch L_Z_DONE
L_Z_NOTMLP:
  s_sub_u32 s60, s2, 144
  s_cmp_lt_u32 s2, 208
  s_cbranch_scc1 WOI_82
  s_cmp_lt_u32 s2, 244
  s_cbranch_scc1 L_Z_DONE
  s_cmp_lt_u32 s2, 252
  s_cbranch_scc0 L_Z_DONE
  s_sub_u32 s60, s2, 180
WOI_82:
  s_lshr_b32 s60, s60, 3
  s_and_b32 s58, s2, 7
  s_mul_i32 s58, s58, 9
  s_add_u32 s60, s60, s58
  s_mul_i32 s70, s60, 57
  s_lshr_b32 s70, s70, 9
  s_mul_i32 s71, s70, 9
  s_sub_u32 s71, s60, s71
  s_lshl_b32 s58, s70, 7
  s_lshl_b32 s59, s71, 12
  s_add_u32 s58, s58, s59
  s_add_u32 s58, s58, 327680
  v_lshrrev_b32 v28, 3, v0
  v_lshlrev_b32 v28, 10, v28
  v_and_b32 v29, 7, v0
  v_lshl_add_u32 v28, v29, 4, v28
  s_mov_b32 exec_lo, -1
  s_mov_b32 exec_hi, 0
  buffer_store_dwordx4 v[24:27], v28, s[16:19], s58 offen sc1
  s_mov_b64 exec, -1
L_Z_DONE:
  v_mov_b32 v23, s56
  s_lshl_b32 s58, s2, 2
  s_add_u32 s58, s58, 57344
  s_waitcnt vmcnt(0)
  s_mov_b64 exec, 1
  buffer_store_dword v23, v9, s[16:19], s58 offen sc1
  s_mov_b64 exec, -1
L_D:
  s_cmp_eq_u32 s75, 2
  s_cbranch_scc1 L_F
  s_sub_u32 s58, s2, 208
  s_cmp_lt_u32 s58, 18
  s_cbranch_scc1 L_D_NOPG
  s_mov_b32 s90, 40000
SP_83:
  ds_read_b32 v22, v9 offset:32
  s_waitcnt lgkmcnt(0)
  v_readfirstlane_b32 s91, v22
  s_nop 3
  s_cmp_eq_u32 s91, 8
  s_cbranch_scc1 SPO_84
  s_sleep 4
  s_sub_u32 s90, s90, 1
  s_cbranch_scc0 SP_83
  s_or_b32 s95, s95, 8192
SPO_84:
L_D_NOPG:
  s_cmp_lt_u32 s2, 144
  s_cbranch_scc1 L_D_MLP
  s_sub_u32 s60, s2, 220
  s_cmp_lt_u32 s60, 36
  s_cbranch_scc0 L_D_NOMODR
  s_add_u32 s60, s60, 18
  s_mov_b64 exec, s[66:67]
  buffer_load_dwordx2 v[24:25], v21, s[48:51], 0 offen
  s_mov_b64 exec, -1
  v_lshrrev_b32 v8, 3, v0
  v_mul_u32_u24 v8, 6912, v8
  v_and_b32 v22, 7, v0
  v_lshl_add_u32 v8, v22, 4, v8
  s_mul_i32 s59, s57, 995328
  s_lshl_b32 s58, s60, 7
  s_add_u32 s59, s59, s58
  s_mov_b32 s61, s59
  buffer_load_dwordx4 v[56:59], v8, s[40:43], s61 offen nt
  s_add_u32 s61, s61, 55296
  buffer_load_dwordx4 v[60:63], v8, s[40:43], s61 offen nt
  s_add_u32 s61, s61, 55296
  buffer_load_dwordx4 v[64:67], v8, s[40:43], s61 offen nt
  s_add_u32 s61, s61, 55296
  buffer_load_dwordx4 v[68:71], v8, s[40:43], s61 offen nt
  s_add_u32 s61, s61, 55296
  buffer_load_dwordx4 v[72:75], v8, s[40:43], s61 offen nt
  s_add_u32 s61, s61, 55296
  buffer_load_dwordx4 v[76:79], v8, s[40:43], s61 offen nt
  s_add_u32 s61, s61, 55296
  buffer_load_dwordx4 v[80:83], v8, s[40:43], s61 offen nt
  s_add_u32 s61, s61, 55296
  buffer_load_dwordx4 v[84:87], v8, s[40:43], s61 offen nt
  s_add_u32 s61, s61, 55296
  buffer_load_dwordx4 v[88:91], v8, s[40:43], s61 offen nt
  s_add_u32 s61, s61, 55296
  buffer_load_dwordx4 v[92:95], v8, s[40:43], s61 offen nt
  s_add_u32 s61, s61, 55296
  buffer_load_dwordx4 v[96:99], v8, s[40:43], s61 offen nt
  s_add_u32 s61, s61, 55296
  s_waitcnt vmcnt(11)
  buffer_load_dwordx4 v[100:103], v8, s[40:43], s61 offen nt
  s_add_u32 s61, s61, 55296
  s_waitcnt vmcnt(11)
  buffer_load_dwordx4 v[104:107], v8, s[40:43], s61 offen nt
  s_add_u32 s61, s61, 55296
  s_waitcnt vmcnt(11)
  buffer_load_dwordx4 v[108:111], v8, s[40:43], s61 offen nt
  s_add_u32 s61, s61, 55296
  s_waitcnt vmcnt(11)
  buffer_load_dwordx4 v[112:115], v8, s[40:43], s61 offen nt
  s_add_u32 s61, s61, 55296
  s_waitcnt vmcnt(11)
  buffer_load_dwordx4 v[116:119], v8, s[40:43], s61 offen nt
  s_add_u32 s61, s61, 55296
  s_waitcnt vmcnt(11)
  buffer_load_dwordx4 v[120:123], v8, s[40:43], s61 offen nt
  s_add_u32 s61, s61, 55296
  s_waitcnt vmcnt(11)
  buffer_load_dwordx4 v[124:127], v8, s[40:43], s61 offen nt
  s_waitcnt vmcnt(18)
  s_mov_b64 exec, s[66:67]
  v_and_b32 v29, s94, v24
  v_and_b32 v31, s94, v25
  v_lshlrev_b32 v28, 16, v24
  v_lshlrev_b32 v30, 16, v25
  v_mul_f32 v32, 0xbfb8aa00, v28
  v_mul_f32 v33, 0xbfb8aa00, v29
  v_mul_f32 v34, 0xbfb8aa00, v30
  v_mul_f32 v35, 0xbfb8aa00, v31
  v_mul_f32 v36, 0xb6a407db, v28
  v_mul_f32 v37, 0xb6a407db, v29
  v_mul_f32 v38, 0xb6a407db, v30
  v_mul_f32 v39, 0xb6a407db, v31
  v_min_f32 v32, 0x42fc0000, v32
  v_min_f32 v33, 0x42fc0000, v33
  v_min_f32 v34, 0x42fc0000, v34
  v_min_f32 v35, 0x42fc0000, v35
  v_exp_f32 v32, v32
  v_exp_f32 v33, v33
  v_exp_f32 v34, v34
  v_exp_f32 v35, v35
  v_fmac_f32 v32, v32, v36
  v_fmac_f32 v33, v33, v37
  v_fmac_f32 v34, v34, v38
  v_fmac_f32 v35, v35, v39
  v_add_f32 v32, 1.0, v32
  v_add_f32 v33, 1.0, v33
  v_add_f32 v34, 1.0, v34
  v_add_f32 v35, 1.0, v35
  v_rcp_f32 v36, v32
  v_rcp_f32 v37, v33
  v_rcp_f32 v38, v34
  v_rcp_f32 v39, v35
  v_mul_f32 v40, v28, v36
  v_mul_f32 v41, v29, v37
  v_mul_f32 v42, v30, v38
  v_mul_f32 v43, v31, v39
  v_fma_f32 v32, -v40, v32, v28
  v_fma_f32 v33, -v41, v33, v29
  v_fma_f32 v34, -v42, v34, v30
  v_fma_f32 v35, -v43, v35, v31
  v_fma_f32 v28, v32, v36, v40
  v_fma_f32 v29, v33, v37, v41
  v_fma_f32 v30, v34, v38, v42
  v_fma_f32 v31, v35, v39, v43
  v_cvt_pk_bf16_f32 v28, v28, v28
  v_cvt_pk_bf16_f32 v29, v29, v29
  v_cvt_pk_bf16_f32 v30, v30, v30
  v_cvt_pk_bf16_f32 v31, v31, v31
  ds_write_b32 v2, v28 offset:0
  ds_write_b32 v2, v29 offset:80
  ds_write_b32 v2, v30 offset:160
  ds_write_b32 v2, v31 offset:240
  s_mov_b64 exec, -1
  ds_read_b128 v[26:29], v1 offset:0
  ds_read_b128 v[30:33], v1 offset:16
  ds_read_b128 v[34:37], v1 offset:32
  ds_read_b128 v[38:41], v1 offset:48
  ds_read_b64 v[42:43], v1 offset:64
  s_waitcnt vmcnt(0)
  s_waitcnt lgkmcnt(0)
  v_and_b32 v44, v26, v4
  v_and_b32 v45, v26, v5
  v_and_b32 v46, v26, v6
  v_and_b32 v47, v26, v7
  s_nop 1
  v_mfma_f32_16x16x32_bf16 v[52:55], v[44:47], v[56:59], 0
  v_and_b32 v48, v27, v4
  v_and_b32 v49, v27, v5
  v_and_b32 v50, v27, v6
  v_and_b32 v51, v27, v7
  s_nop 1
  v_mfma_f32_16x16x32_bf16 v[52:55], v[48:51], v[60:63], v[52:55]
  v_and_b32 v44, v28, v4
  v_and_b32 v45, v28, v5
  v_and_b32 v46, v28, v6
  v_and_b32 v47, v28, v7
  s_nop 1
  v_mfma_f32_16x16x32_bf16 v[52:55], v[44:47], v[64:67], v[52:55]
  v_and_b32 v48, v29, v4
  v_and_b32 v49, v29, v5
  v_and_b32 v50, v29, v6
  v_and_b32 v51, v29, v7
  s_nop 1
  v_mfma_f32_16x16x32_bf16 v[52:55], v[48:51], v[68:71], v[52:55]
  v_and_b32 v44, v30, v4
  v_and_b32 v45, v30, v5
  v_and_b32 v46, v30, v6
  v_and_b32 v47, v30, v7
  s_nop 1
  v_mfma_f32_16x16x32_bf16 v[52:55], v[44:47], v[72:75], v[52:55]
  v_and_b32 v48, v31, v4
  v_and_b32 v49, v31, v5
  v_and_b32 v50, v31, v6
  v_and_b32 v51, v31, v7
  s_nop 1
  v_mfma_f32_16x16x32_bf16 v[52:55], v[48:51], v[76:79], v[52:55]
  v_and_b32 v44, v32, v4
  v_and_b32 v45, v32, v5
  v_and_b32 v46, v32, v6
  v_and_b32 v47, v32, v7
  s_nop 1
  v_mfma_f32_16x16x32_bf16 v[52:55], v[44:47], v[80:83], v[52:55]
  v_and_b32 v48, v33, v4
  v_and_b32 v49, v33, v5
  v_and_b32 v50, v33, v6
  v_and_b32 v51, v33, v7
  s_nop 1
  v_mfma_f32_16x16x32_bf16 v[52:55], v[48:51], v[84:87], v[52:55]
  v_and_b32 v44, v34, v4
  v_and_b32 v45, v34, v5
  v_and_b32 v46, v34, v6
  v_and_b32 v47, v34, v7
  s_nop 1
  v_mfma_f32_16x16x32_bf16 v[52:55], v[44:47], v[88:91], v[52:55]
  v_and_b32 v48, v35, v4
  v_and_b32 v49, v35, v5
  v_and_b32 v50, v35, v6
  v_and_b32 v51, v35, v7
  s_nop 1
  v_mfma_f32_16x16x32_bf16 v[52:55], v[48:51], v[92:95], v[52:55]
  v_and_b32 v44, v36, v4
  v_and_b32 v45, v36, v5
  v_and_b32 v46, v36, v6
  v_and_b32 v47, v36, v7
  s_nop 1
  v_mfma_f32_16x16x32_bf16 v[52:55], v[44:47], v[96:99], v[52:55]
  v_and_b32 v48, v37, v4
  v_and_b32 v49, v37, v5
  v_and_b32 v50, v37, v6
  v_and_b32 v51, v37, v7
  s_nop 1
  v_mfma_f32_16x16x32_bf16 v[52:55], v[48:51], v[100:103], v[52:55]
  v_and_b32 v44, v38, v4
  v_and_b32 v45, v38, v5
  v_and_b32 v46, v38, v6
  v_and_b32 v47, v38, v7
  s_nop 1
  v_mfma_f32_16x16x32_bf16 v[52:55], v[44:47], v[104:107], v[52:55]
  v_and_b32 v48, v39, v4
  v_and_b32 v49, v39, v5
  v_and_b32 v50, v39, v6
  v_and_b32 v51, v39, v7
  s_nop 1
  v_mfma_f32_16x16x32_bf16 v[52:55], v[48:51], v[108:111], v[52:55]
  v_and_b32 v44, v40, v4
  v_and_b32 v45, v40, v5
  v_and_b32 v46, v40, v6
  v_and_b32 v47, v40, v7
  s_nop 1
  v_mfma_f32_16x16x32_bf16 v[52:55], v[44:47], v[112:115], v[52:55]
  v_and_b32 v48, v41, v4
  v_and_b32 v49, v41, v5
  v_and_b32 v50, v41, v6
  v_and_b32 v51, v41, v7
  s_nop 1
  v_mfma_f32_16x16x32_bf16 v[52:55], v[48:51], v[116:119], v[52:55]
  v_and_b32 v44, v42, v4
  v_and_b32 v45, v42, v5
  v_and_b32 v46, v42, v6
  v_and_b32 v47, v42, v7
  s_nop 1
  v_mfma_f32_16x16x32_bf16 v[52:55], v[44:47], v[120:123], v[52:55]
  v_and_b32 v48, v43, v4
  v_and_b32 v49, v43, v5
  v_and_b32 v50, v43, v6
  v_and_b32 v51, v43, v7
  s_nop 1
  v_mfma_f32_16x16x32_bf16 v[52:55], v[48:51], v[124:127], v[52:55]
  s_mov_b32 exec_lo, 0x00ff00ff
  s_mov_b32 exec_hi, 0xff00ff00
  s_nop 5
  ds_write_b128 v3, v[52:55] offset:15104
  s_mov_b64 exec, -1
  s_mov_b64 exec, 1
  v_mov_b32 v22, 1
  s_waitcnt lgkmcnt(0)
  ds_add_rtn_u32 v23, v9, v22 offset:20
  s_waitcnt lgkmcnt(0)
  v_readfirstlane_b32 s91, v23
  s_mov_b64 exec, -1
  s_nop 2
  s_cmp_eq_u32 s91, 3
  s_cbranch_scc0 MODSKIP_85
  s_mov_b64 exec, 0xffff
  v_lshlrev_b32 v22, 4, v0
  ds_read_b128 v[24:27], v22 offset:15104
  ds_read_b128 v[28:31], v22 offset:15392
  ds_read_b128 v[32:35], v22 offset:15680
  ds_read_b128 v[36:39], v22 offset:15968
  ds_read_b128 v[40:43], v22 offset:16256
  ds_read_b128 v[44:47], v22 offset:16544
  ds_read_b128 v[48:51], v22 offset:16832
  ds_read_b128 v[52:55], v22 offset:17120
  s_waitcnt lgkmcnt(0)
  v_add_f32 v24, v24, v40
  v_add_f32 v25, v25, v41
  v_add_f32 v26, v26, v42
  v_add_f32 v27, v27, v43
  v_add_f32 v28, v28, v44
  v_add_f32 v29, v29, v45
  v_add_f32 v30, v30, v46
  v_add_f32 v31, v31, v47
  v_add_f32 v32, v32, v48
  v_add_f32 v33, v33, v49
  v_add_f32 v34, v34, v50
  v_add_f32 v35, v35, v51
  v_add_f32 v36, v36, v52
  v_add_f32 v37, v37, v53
  v_add_f32 v38, v38, v54
  v_add_f32 v39, v39, v55
  v_add_f32 v24, v24, v32
  v_add_f32 v25, v25, v33
  v_add_f32 v26, v26, v34
  v_add_f32 v27, v27, v35
  v_add_f32 v28, v28, v36
  v_add_f32 v29, v29, v37
  v_add_f32 v30, v30, v38
  v_add_f32 v31, v31, v39
  v_add_f32 v24, v24, v28
  v_add_f32 v25, v25, v29
  v_add_f32 v26, v26, v30
  v_add_f32 v27, v27, v31
  s_lshl_b32 s58, s60, 8
  s_add_u32 s58, s58, 4096
  v_cvt_pk_bf16_f32 v24, v24, v25
  v_cvt_pk_bf16_f32 v26, v26, v27
  v_mov_b32 v25, s56
  v_mov_b32 v27, s56
  buffer_store_dwordx4 v[24:27], v22, s[16:19], s58 offen sc1
  s_mov_b64 exec, -1
MODSKIP_85:
L_D_NOMODR:
  s_branch L_D_END
L_D_MLP:
  s_and_b32 s60, s2, 0xf0
  s_and_b32 s58, s2, 7
  s_lshl_b32 s58, s58, 1
  s_add_u32 s60, s60, s58
  s_bfe_u32 s58, s2, 0x10003
  s_add_u32 s60, s60, s58
  v_lshrrev_b32 v8, 3, v0
  v_mul_u32_u24 v8, 9216, v8
  v_and_b32 v22, 3, v0
  v_lshl_add_u32 v8, v22, 4, v8
  s_mul_i32 s58, s57, 73728
  s_lshl_b32 s59, s60, 6
  s_add_u32 s58, s58, s59
  s_mov_b32 s61, s58
  s_mov_b64 exec, s[62:63]
  buffer_load_dwordx4 v[56:59], v8, s[28:31], s61 offen nt
  s_mov_b64 exec, s[64:65]
  buffer_load_dwordx4 v[56:59], v8, s[32:35], s61 offen nt
  s_add_u32 s61, s61, 294912
  s_mov_b64 exec, s[62:63]
  buffer_load_dwordx4 v[60:63], v8, s[28:31], s61 offen nt
  s_mov_b64 exec, s[64:65]
  buffer_load_dwordx4 v[60:63], v8, s[32:35], s61 offen nt
  s_add_u32 s61, s61, 294912
  s_mov_b64 exec, s[62:63]
  buffer_load_dwordx4 v[64:67], v8, s[28:31], s61 offen nt
  s_mov_b64 exec, s[64:65]
  buffer_load_dwordx4 v[64:67], v8, s[32:35], s61 offen nt
  s_add_u32 s61, s61, 294912
  s_mov_b64 exec, s[62:63]
  buffer_load_dwordx4 v[68:71], v8, s[28:31], s61 offen nt
  s_mov_b64 exec, s[64:65]
  buffer_load_dwordx4 v[68:71], v8, s[32:35], s61 offen nt
  s_add_u32 s61, s61, 294912
  s_mov_b64 exec, s[62:63]
  buffer_load_dwordx4 v[72:75], v8, s[28:31], s61 offen nt
  s_mov_b64 exec, s[64:65]
  buffer_load_dwordx4 v[72:75], v8, s[32:35], s61 offen nt
  s_add_u32 s61, s61, 294912
  s_mov_b64 exec, s[62:63]
  buffer_load_dwordx4 v[76:79], v8, s[28:31], s61 offen nt
  s_mov_b64 exec, s[64:65]
  buffer_load_dwordx4 v[76:79], v8, s[32:35], s61 offen nt
  s_add_u32 s61, s61, 294912
  s_waitcnt vmcnt(10)
  s_mov_b64 exec, s[62:63]
  buffer_load_dwordx4 v[80:83], v8, s[28:31], s61 offen nt
  s_mov_b64 exec, s[64:65]
  buffer_load_dwordx4 v[80:83], v8, s[32:35], s61 offen nt
  s_add_u32 s61, s61, 294912
  s_waitcnt vmcnt(10)
  s_mov_b64 exec, s[62:63]
  buffer_load_dwordx4 v[84:87], v8, s[28:31], s61 offen nt
  s_mov_b64 exec, s[64:65]
  buffer_load_dwordx4 v[84:87], v8, s[32:35], s61 offen nt
  s_add_u32 s61, s61, 294912
  s_waitcnt vmcnt(10)
  s_mov_b64 exec, s[62:63]
  buffer_load_dwordx4 v[88:91], v8, s[28:31], s61 offen nt
  s_mov_b64 exec, s[64:65]
  buffer_load_dwordx4 v[88:91], v8, s[32:35], s61 offen nt
  s_add_u32 s61, s61, 294912
  s_waitcnt vmcnt(10)
  s_mov_b64 exec, s[62:63]
  buffer_load_dwordx4 v[92:95], v8, s[28:31], s61 offen nt
  s_mov_b64 exec, s[64:65]
  buffer_load_dwordx4 v[92:95], v8, s[32:35], s61 offen nt
  s_add_u32 s61, s61, 294912
  s_waitcnt vmcnt(10)
  s_mov_b64 exec, s[62:63]
  buffer_load_dwordx4 v[96:99], v8, s[28:31], s61 offen nt
  s_mov_b64 exec, s[64:65]
  buffer_load_dwordx4 v[96:99], v8, s[32:35], s61 offen nt
  s_add_u32 s61, s61, 294912
  s_waitcnt vmcnt(10)
  s_mov_b64 exec, s[62:63]
  buffer_load_dwordx4 v[100:103], v8, s[28:31], s61 offen nt
  s_mov_b64 exec, s[64:65]
  buffer_load_dwordx4 v[100:103], v8, s[32:35], s61 offen nt
  s_mov_b64 exec, -1
L_D_END:
  s_cmp_eq_u32 s75, 1
  s_cbranch_scc0 L_F
  s_mov_b32 s75, 2
  s_branch L_X1B
L_F:
  s_cmp_lg_u32 s57, 0
  s_cbranch_scc1 L_E
  s_mov_b32 s90, 40000
SP_86:
  ds_read_b32 v22, v9 offset:8
  s_waitcnt lgkmcnt(0)
  v_readfirstlane_b32 s91, v22
  s_nop 3
  s_cmp_eq_u32 s91, 8
  s_cbranch_scc1 SPO_87
  s_sleep 1
  s_sub_u32 s90, s90, 1
  s_cbranch_scc0 SP_86
  s_or_b32 s95, s95, 64
SPO_87:
  s_memrealtime s[72:73]
  v_lshlrev_b32 v22, 3, v0
  ds_read_b64 v[24:25], v22 offset:1024
  s_waitcnt lgkmcnt(0)
  v_mov_b32 v26, v24
  s_nop 1
  v_max_f32_dpp v26, v26, v26 quad_perm:[1,0,3,2] row_mask:0xf bank_mask:0xf
  s_nop 1
  v_max_f32_dpp v26, v26, v26 quad_perm:[2,3,0,1] row_mask:0xf bank_mask:0xf
  s_nop 1
  v_max_f32_dpp v26, v26, v26 row_half_mirror row_mask:0xf bank_mask:0xf
  s_nop 1
  v_max_f32_dpp v26, v26, v26 row_mirror row_mask:0xf bank_mask:0xf
  v_mov_b32 v27, v26
  s_nop 1
  v_permlane16_swap_b32 v26, v27
  v_max_f32 v26, v26, v27
  v_sub_f32 v24, v24, v26
  v_mul_f32 v24, 0x3fb8aa3b, v24
  v_exp_f32 v24, v24
  s_nop 0
  v_mul_f32 v25, v25, v24
  s_nop 1
  v_add_f32_dpp v25, v25, v25 quad_perm:[1,0,3,2] row_mask:0xf bank_mask:0xf
  s_nop 1
  v_add_f32_dpp v25, v25, v25 quad_perm:[2,3,0,1] row_mask:0xf bank_mask:0xf
  s_nop 1
  v_add_f32_dpp v25, v25, v25 row_half_mirror row_mask:0xf bank_mask:0xf
  s_nop 1
  v_add_f32_dpp v25, v25, v25 row_mirror row_mask:0xf bank_mask:0xf
  v_mov_b32 v27, v25
  s_nop 1
  v_permlane16_swap_b32 v25, v27
  v_add_f32 v25, v25, v27
  v_mov_b32 v24, v26
  v_mov_b32 v26, s72
  v_mov_b32 v27, s56
  v_lshrrev_b32 v22, 5, v0
  v_lshlrev_b32 v22, 8, v22
  s_lshl_b32 s58, s68, 9
  s_add_u32 s58, s58, 49152
  s_lshl_b32 s59, s69, 4
  s_add_u32 s59, s59, s58
  s_mov_b32 exec_lo, 1
  s_mov_b32 exec_hi, 1
  buffer_store_dwordx4 v[24:27], v22, s[16:19], s59 offen sc1
  s_mov_b64 exec, -1
  v_and_b32 v22, 31, v0
  v_lshlrev_b32 v22, 4, v22
  s_mov_b32 s90, 4000
PL_88:
  buffer_load_dwordx4 v[28:31], v22, s[16:19], s58 offen offset:0 sc1
  s_waitcnt vmcnt(0)
  v_xor_b32 v32, s56, v31
  v_cmp_eq_u32 vcc, 0, v32
  s_nop 3
  s_cmp_eq_u64 vcc, -1
  s_cbranch_scc1 PLO_89
  s_sleep 2
  s_sub_u32 s90, s90, 1
  s_cbranch_scc0 PL_88
  s_or_b32 s95, s95, 128
PLO_89:
  v_mov_b32 v26, v28
  s_nop 1
  v_max_f32_dpp v26, v26, v26 quad_perm:[1,0,3,2] row_mask:0xf bank_mask:0xf
  s_nop 1
  v_max_f32_dpp v26, v26, v26 quad_perm:[2,3,0,1] row_mask:0xf bank_mask:0xf
  s_nop 1
  v_max_f32_dpp v26, v26, v26 row_half_mirror row_mask:0xf bank_mask:0xf
  s_nop 1
  v_max_f32_dpp v26, v26, v26 row_mirror row_mask:0xf bank_mask:0xf
  v_sub_f32 v28, v28, v26
  v_mul_f32 v28, 0x3fb8aa3b, v28
  v_exp_f32 v28, v28
  s_nop 0
  v_mul_f32 v27, v29, v28
  s_nop 1
  v_add_f32_dpp v27, v27, v27 quad_perm:[1,0,3,2] row_mask:0xf bank_mask:0xf
  s_nop 1
  v_add_f32_dpp v27, v27, v27 quad_perm:[2,3,0,1] row_mask:0xf bank_mask:0xf
  s_nop 1
  v_add_f32_dpp v27, v27, v27 row_half_mirror row_mask:0xf bank_mask:0xf
  s_nop 1
  v_add_f32_dpp v27, v27, v27 row_mirror row_mask:0xf bank_mask:0xf
  v_rcp_f32 v27, v27
  v_lshrrev_b32 v22, 4, v0
  v_lshlrev_b32 v22, 3, v22
  s_mov_b32 exec_lo, 0x00010001
  s_mov_b32 exec_hi, 0
  ds_write_b64 v22, v[26:27] offset:64
  s_mov_b64 exec, -1
  v_subrev_u32 v30, s72, v30
  s_nop 1
  v_add_u32_dpp v30, v30, v30 quad_perm:[1,0,3,2] row_mask:0xf bank_mask:0xf
  s_nop 1
  v_add_u32_dpp v30, v30, v30 quad_perm:[2,3,0,1] row_mask:0xf bank_mask:0xf
  s_nop 1
  v_add_u32_dpp v30, v30, v30 row_half_mirror row_mask:0xf bank_mask:0xf
  s_nop 1
  v_add_u32_dpp v30, v30, v30 row_mirror row_mask:0xf bank_mask:0xf
  s_nop 0
  v_readfirstlane_b32 s73, v30
  s_nop 3
  s_ashr_i32 s73, s73, 4
  s_add_u32 s72, s72, s73
  v_mov_b32 v23, s72
  ds_write_b32 v9, v23 offset:52
  v_mov_b32 v23, 1
  s_waitcnt lgkmcnt(0)
  ds_write_b32 v9, v23 offset:4
L_E:
  s_cmp_lt_u32 s2, 208
  s_cbranch_scc1 L_E_GO
  s_cmp_lt_u32 s2, 244
  s_cbranch_scc1 L_E_NOTAIL
  s_cmp_lt_u32 s2, 252
  s_cbranch_scc1 L_E_GO
L_E_NOTAIL:
  s_branch L_AUX_END
L_E_GO:
  s_mov_b32 s90, 40000
SP_90:
  ds_read_b32 v22, v9 offset:4
  s_waitcnt lgkmcnt(0)
  v_readfirstlane_b32 s91, v22
  s_nop 3
  s_cmp_eq_u32 s91, 1
  s_cbranch_scc1 SPO_91
  s_sleep 8
  s_sub_u32 s90, s90, 1
  s_cbranch_scc0 SP_90
  s_or_b32 s95, s95, 16384
SPO_91:
  s_cmp_lt_u32 s2, 144
  s_cbranch_scc0 L_ST_WO
  s_waitcnt vmcnt(0)
  v_lshrrev_b32 v24, 3, v0
  v_and_b32 v25, 7, v0
  v_lshlrev_b32 v25, 4, v25
  v_mul_u32_u24 v22, 144, v24
  v_add_u32 v22, v22, v25
  s_mul_i32 s58, s57, 1152
  s_add_u32 s58, s58, 29184
  v_add_u32 v22, s58, v22
  v_add_u32 v23, 41472, v22
  ds_write_b128 v22, v[56:59] offset:0
  ds_write_b128 v22, v[60:63] offset:4608
  ds_write_b128 v22, v[64:67] offset:9216
  ds_write_b128 v22, v[68:71] offset:13824
  ds_write_b128 v22, v[72:75] offset:18432
  ds_write_b128 v22, v[76:79] offset:23040
  ds_write_b128 v22, v[80:83] offset:27648
  ds_write_b128 v22, v[84:87] offset:32256
  ds_write_b128 v22, v[88:91] offset:36864
  ds_write_b128 v23, v[92:95] offset:0
  ds_write_b128 v23, v[96:99] offset:4608
  ds_write_b128 v23, v[100:103] offset:9216
  v_mov_b32 v24, 0
  v_mov_b32 v25, 0
  v_mov_b32 v26, 0
  v_mov_b32 v27, 0
  s_mul_i32 s58, s57, 384
  s_add_u32 s58, s58, 23552
  v_lshlrev_b32 v22, 4, v0
  v_add_u32 v22, s58, v22
  s_mov_b64 exec, 0xffffff
  ds_write_b128 v22, v[24:27]
  s_mov_b64 exec, -1
  s_mov_b64 exec, 1
  v_mov_b32 v22, 1
  s_waitcnt lgkmcnt(0)
  ds_add_u32 v9, v22 offset:24
  s_mov_b64 exec, -1
  s_mov_b32 s90, 40000
SP_92:
  ds_read_b32 v22, v9 offset:24
  s_waitcnt lgkmcnt(0)
  v_readfirstlane_b32 s91, v22
  s_nop 3
  s_cmp_eq_u32 s91, 4
  s_cbranch_scc1 SPO_93
  s_sleep 2
  s_sub_u32 s90, s90, 1
  s_cbranch_scc0 SP_92
  s_or_b32 s95, s95, 32768
SPO_93:
  v_lshrrev_b32 v22, 4, v0
  v_lshlrev_b32 v22, 3, v22
  v_bfe_u32 v23, v0, 2, 2
  v_add_u32 v22, v22, v23
  v_mul_u32_u24 v22, 144, v22
  v_and_b32 v23, 3, v0
  v_and_b32 v24, 1, v23
  v_lshl_add_u32 v22, v24, 3, v22
  v_lshrrev_b32 v24, 1, v23
  v_lshl_add_u32 v22, v24, 6, v22
  s_lshl_b32 s58, s57, 4
  s_add_u32 s58, s58, 29184
  v_add_u32 v22, s58, v22
  v_add_u32 v23, 41472, v22
  ds_read_b64_tr_b16 v[56:57], v22 offset:0
  ds_read_b64_tr_b16 v[58:59], v22 offset:576
  ds_read_b64_tr_b16 v[60:61], v22 offset:4608
  ds_read_b64_tr_b16 v[62:63], v22 offset:5184
  ds_read_b64_tr_b16 v[64:65], v22 offset:9216
  ds_read_b64_tr_b16 v[66:67], v22 offset:9792
  ds_read_b64_tr_b16 v[68:69], v22 offset:13824
  ds_read_b64_tr_b16 v[70:71], v22 offset:14400
  ds_read_b64_tr_b16 v[72:73], v22 offset:18432
  ds_read_b64_tr_b16 v[74:75], v22 offset:19008
  ds_read_b64_tr_b16 v[76:77], v22 offset:23040
  ds_read_b64_tr_b16 v[78:79], v22 offset:23616
  ds_read_b64_tr_b16 v[80:81], v22 offset:27648
  ds_read_b64_tr_b16 v[82:83], v22 offset:28224
  ds_read_b64_tr_b16 v[84:85], v22 offset:32256
  ds_read_b64_tr_b16 v[86:87], v22 offset:32832
  ds_read_b64_tr_b16 v[88:89], v22 offset:36864
  ds_read_b64_tr_b16 v[90:91], v22 offset:37440
  ds_read_b64_tr_b16 v[92:93], v23 offset:0
  ds_read_b64_tr_b16 v[94:95], v23 offset:576
  ds_read_b64_tr_b16 v[96:97], v23 offset:4608
  ds_read_b64_tr_b16 v[98:99], v23 offset:5184
  ds_read_b64_tr_b16 v[100:101], v23 offset:9216
  ds_read_b64_tr_b16 v[102:103], v23 offset:9792
  s_waitcnt lgkmcnt(0)
  s_branch L_ST_DONE
L_ST_WO:
  s_sub_u32 s60, s2, 144
  s_cmp_lt_u32 s2, 208
  s_cbranch_scc1 WOI_95
  s_sub_u32 s60, s2, 180
WOI_95:
  s_lshr_b32 s60, s60, 3
  s_and_b32 s58, s2, 7
  s_mul_i32 s58, s58, 9
  s_add_u32 s60, s60, s58
  s_mul_i32 s70, s60, 57
  s_lshr_b32 s70, s70, 9
  s_mul_i32 s71, s70, 9
  s_sub_u32 s71, s60, s71
  v_lshrrev_b32 v8, 3, v0
  v_mul_u32_u24 v8, 1152, v8
  v_and_b32 v22, 7, v0
  v_lshl_add_u32 v8, v22, 4, v8
  s_lshl_b32 s58, s70, 9
  s_lshl_b32 s59, s57, 7
  s_add_u32 s58, s58, s59
  s_mul_i32 s58, s58, 1152
  s_lshl_b32 s59, s71, 7
  s_add_u32 s58, s58, s59
  s_mov_b32 s61, s58
  buffer_load_dwordx4 v[56:59], v8, s[24:27], s61 offen nt
  s_add_u32 s61, s61, 9216
  buffer_load_dwordx4 v[60:63], v8, s[24:27], s61 offen nt
  s_add_u32 s61, s61, 9216
  buffer_load_dwordx4 v[64:67], v8, s[24:27], s61 offen nt
  s_add_u32 s61, s61, 9216
  buffer_load_dwordx4 v[68:71], v8, s[24:27], s61 offen nt
  s_add_u32 s61, s61, 9216
  s_waitcnt vmcnt(3)
  buffer_load_dwordx4 v[72:75], v8, s[24:27], s61 offen nt
  s_add_u32 s61, s61, 9216
  s_waitcnt vmcnt(3)
  buffer_load_dwordx4 v[76:79], v8, s[24:27], s61 offen nt
  s_add_u32 s61, s61, 9216
  s_waitcnt vmcnt(3)
  buffer_load_dwordx4 v[80:83], v8, s[24:27], s61 offen nt
  s_add_u32 s61, s61, 9216
  s_waitcnt vmcnt(3)
  buffer_load_dwordx4 v[84:87], v8, s[24:27], s61 offen nt
  s_add_u32 s61, s61, 9216
  s_waitcnt vmcnt(3)
  buffer_load_dwordx4 v[88:91], v8, s[24:27], s61 offen nt
  s_add_u32 s61, s61, 9216
  s_waitcnt vmcnt(3)
  buffer_load_dwordx4 v[92:95], v8, s[24:27], s61 offen nt
  s_add_u32 s61, s61, 9216
  s_waitcnt vmcnt(3)
  buffer_load_dwordx4 v[96:99], v8, s[24:27], s61 offen nt
  s_add_u32 s61, s61, 9216
  s_waitcnt vmcnt(3)
  buffer_load_dwordx4 v[100:103], v8, s[24:27], s61 offen nt
  s_add_u32 s61, s61, 9216
  s_waitcnt vmcnt(3)
  buffer_load_dwordx4 v[104:107], v8, s[24:27], s61 offen nt
  s_add_u32 s61, s61, 9216
  s_waitcnt vmcnt(3)
  buffer_load_dwordx4 v[108:111], v8, s[24:27], s61 offen nt
  s_add_u32 s61, s61, 9216
  s_waitcnt vmcnt(3)
  buffer_load_dwordx4 v[112:115], v8, s[24:27], s61 offen nt
  s_add_u32 s61, s61, 9216
  s_waitcnt vmcnt(3)
  buffer_load_dwordx4 v[116:119], v8, s[24:27], s61 offen nt
  s_waitcnt vmcnt(0)
  v_lshrrev_b32 v24, 3, v0
  v_and_b32 v25, 7, v0
  v_mul_u32_u24 v22, 144, v24
  v_lshl_add_u32 v22, v25, 4, v22
  s_mul_i32 s58, s57, 18432
  s_add_u32 s58, s58, 29184
  v_add_u32 v22, s58, v22
  ds_write_b128 v22, v[56:59] offset:0
  ds_write_b128 v22, v[60:63] offset:1152
  ds_write_b128 v22, v[64:67] offset:2304
  ds_write_b128 v22, v[68:71] offset:3456
  ds_write_b128 v22, v[72:75] offset:4608
  ds_write_b128 v22, v[76:79] offset:5760
  ds_write_b128 v22, v[80:83] offset:6912
  ds_write_b128 v22, v[84:87] offset:8064
  ds_write_b128 v22, v[88:91] offset:9216
  ds_write_b128 v22, v[92:95] offset:10368
  ds_write_b128 v22, v[96:99] offset:11520
  ds_write_b128 v22, v[100:103] offset:12672
  ds_write_b128 v22, v[104:107] offset:13824
  ds_write_b128 v22, v[108:111] offset:14976
  ds_write_b128 v22, v[112:115] offset:16128
  ds_write_b128 v22, v[116:119] offset:17280
  s_mov_b64 exec, 1
  v_mov_b32 v22, 1
  s_waitcnt lgkmcnt(0)
  ds_add_u32 v9, v22 offset:24
  s_mov_b64 exec, -1
  s_mov_b32 s90, 40000
SP_96:
  ds_read_b32 v22, v9 offset:24
  s_waitcnt lgkmcnt(0)
  v_readfirstlane_b32 s91, v22
  s_nop 3
  s_cmp_eq_u32 s91, 4
  s_cbranch_scc1 SPO_97
  s_sleep 2
  s_sub_u32 s90, s90, 1
  s_cbranch_scc0 SP_96
  s_or_b32 s95, s95, 32768
SPO_97:
  v_lshrrev_b32 v22, 4, v0
  v_lshlrev_b32 v22, 3, v22
  v_bfe_u32 v23, v0, 2, 2
  v_add_u32 v22, v22, v23
  v_mul_u32_u24 v22, 144, v22
  v_and_b32 v23, 3, v0
  v_lshl_add_u32 v22, v23, 3, v22
  s_lshl_b32 s58, s57, 5
  s_add_u32 s58, s58, 29184
  v_add_u32 v22, s58, v22
  v_add_u32 v23, 36864, v22
  ds_read_b64_tr_b16 v[56:57], v22 offset:0
  ds_read_b64_tr_b16 v[58:59], v22 offset:576
  ds_read_b64_tr_b16 v[60:61], v22 offset:4608
  ds_read_b64_tr_b16 v[62:63], v22 offset:5184
  ds_read_b64_tr_b16 v[64:65], v22 offset:9216
  ds_read_b64_tr_b16 v[66:67], v22 offset:9792
  ds_read_b64_tr_b16 v[68:69], v22 offset:13824
  ds_read_b64_tr_b16 v[70:71], v22 offset:14400
  ds_read_b64_tr_b16 v[72:73], v22 offset:18432
  ds_read_b64_tr_b16 v[74:75], v22 offset:19008
  ds_read_b64_tr_b16 v[76:77], v22 offset:23040
  ds_read_b64_tr_b16 v[78:79], v22 offset:23616
  ds_read_b64_tr_b16 v[80:81], v22 offset:27648
  ds_read_b64_tr_b16 v[82:83], v22 offset:28224
  ds_read_b64_tr_b16 v[84:85], v22 offset:32256
  ds_read_b64_tr_b16 v[86:87], v22 offset:32832
  ds_read_b64_tr_b16 v[88:89], v23 offset:0
  ds_read_b64_tr_b16 v[90:91], v23 offset:576
  ds_read_b64_tr_b16 v[92:93], v23 offset:4608
  ds_read_b64_tr_b16 v[94:95], v23 offset:5184
  ds_read_b64_tr_b16 v[96:97], v23 offset:9216
  ds_read_b64_tr_b16 v[98:99], v23 offset:9792
  ds_read_b64_tr_b16 v[100:101], v23 offset:13824
  ds_read_b64_tr_b16 v[102:103], v23 offset:14400
  ds_read_b64_tr_b16 v[104:105], v23 offset:18432
  ds_read_b64_tr_b16 v[106:107], v23 offset:19008
  ds_read_b64_tr_b16 v[108:109], v23 offset:23040
  ds_read_b64_tr_b16 v[110:111], v23 offset:23616
  ds_read_b64_tr_b16 v[112:113], v23 offset:27648
  ds_read_b64_tr_b16 v[114:115], v23 offset:28224
  ds_read_b64_tr_b16 v[116:117], v23 offset:32256
  ds_read_b64_tr_b16 v[118:119], v23 offset:32832
  s_waitcnt lgkmcnt(0)
L_ST_DONE:
  v_lshlrev_b32 v22, 4, v0
  s_mov_b32 s58, 57344
  s_mov_b32 s90, 4000
PL_98:
  buffer_load_dwordx4 v[24:27], v22, s[16:19], s58 offen offset:0 sc1
  s_waitcnt vmcnt(0)
  v_xor_b32 v28, s56, v24
  v_xor_b32 v23, s56, v25
  v_or_b32 v28, v28, v23
  v_xor_b32 v23, s56, v26
  v_or_b32 v28, v28, v23
  v_xor_b32 v23, s56, v27
  v_or_b32 v28, v28, v23
  v_cmp_eq_u32 vcc, 0, v28
  s_nop 3
  s_cmp_eq_u64 vcc, -1
  s_cbranch_scc1 PLO_99
  s_sleep 8
  s_sub_u32 s90, s90, 1
  s_cbranch_scc0 PL_98
  s_or_b32 s95, s95, 32
PLO_99:
  s_cmp_lt_u32 s2, 144
  s_cbranch_scc0 L_G_WO
  s_mov_b64 exec, s[66:67]
  buffer_load_dwordx2 v[44:45], v21, s[44:47], 0 offen
  s_mov_b32 s58, 8704
  s_mov_b32 s90, 4000
PL_100:
  buffer_load_dwordx4 v[24:27], v18, s[16:19], s58 offen offset:0 sc1
  buffer_load_dwordx4 v[28:31], v18, s[16:19], s58 offen offset:2304 sc1
  s_waitcnt vmcnt(0)
  v_xor_b32 v40, s56, v25
  v_xor_b32 v23, s56, v27
  v_or_b32 v40, v40, v23
  v_xor_b32 v23, s56, v29
  v_or_b32 v40, v40, v23
  v_xor_b32 v23, s56, v31
  v_or_b32 v40, v40, v23
  v_cmp_eq_u32 vcc, 0, v40
  s_nop 3
  s_cmp_eq_u64 vcc, s[66:67]
  s_cbranch_scc1 PLO_101
  s_sleep 8
  s_sub_u32 s90, s90, 1
  s_cbranch_scc0 PL_100
  s_or_b32 s95, s95, 512
PLO_101:
  v_and_b32 v15, s94, v24
  v_and_b32 v17, s94, v26
  v_lshlrev_b32 v14, 16, v24
  v_lshlrev_b32 v16, 16, v26
  v_and_b32 v49, s94, v28
  v_and_b32 v51, s94, v30
  v_lshlrev_b32 v48, 16, v28
  v_lshlrev_b32 v50, 16, v30
  s_mov_b32 s58, 13312
  s_mov_b32 s90, 4000
PL_102:
  buffer_load_dwordx4 v[24:27], v18, s[16:19], s58 offen offset:0 sc1
  buffer_load_dwordx4 v[28:31], v18, s[16:19], s58 offen offset:2304 sc1
  s_waitcnt vmcnt(0)
  v_xor_b32 v40, s56, v25
  v_xor_b32 v23, s56, v27
  v_or_b32 v40, v40, v23
  v_xor_b32 v23, s56, v29
  v_or_b32 v40, v40, v23
  v_xor_b32 v23, s56, v31
  v_or_b32 v40, v40, v23
  v_cmp_eq_u32 vcc, 0, v40
  s_nop 3
  s_cmp_eq_u64 vcc, s[66:67]
  s_cbranch_scc1 PLO_103
  s_sleep 8
  s_sub_u32 s90, s90, 1
  s_cbranch_scc0 PL_102
  s_or_b32 s95, s95, 512
PLO_103:
  v_and_b32 v165, s94, v24
  v_and_b32 v167, s94, v26
  v_lshlrev_b32 v164, 16, v24
  v_lshlrev_b32 v166, 16, v26
  v_add_f32 v164, 1.0, v164
  v_add_f32 v165, 1.0, v165
  v_add_f32 v166, 1.0, v166
  v_add_f32 v167, 1.0, v167
  v_cvt_pk_bf16_f32 v164, 0, v164
  v_cvt_pk_bf16_f32 v165, 0, v165
  v_cvt_pk_bf16_f32 v166, 0, v166
  v_cvt_pk_bf16_f32 v167, 0, v167
  v_and_b32 v33, s94, v28
  v_and_b32 v35, s94, v30
  v_lshlrev_b32 v32, 16, v28
  v_lshlrev_b32 v34, 16, v30
  ds_write_b128 v18, v[32:35] offset:19712
  v_and_b32 v11, s94, v44
  v_and_b32 v13, s94, v45
  v_lshlrev_b32 v10, 16, v44
  v_lshlrev_b32 v12, 16, v45
  v_cvt_pk_bf16_f32 v20, v48, v49
  v_cvt_pk_bf16_f32 v21, v50, v51
  s_mov_b64 exec, -1
  s_mov_b32 s90, 80000
SP_104:
  ds_read_b32 v22, v9 offset:40
  s_waitcnt lgkmcnt(0)
  v_readfirstlane_b32 s91, v22
  s_nop 3
  s_cmp_eq_u32 s91, 8
  s_cbranch_scc1 SPO_105
  s_sleep 4
  s_sub_u32 s90, s90, 1
  s_cbranch_scc0 SP_104
  s_or_b32 s95, s95, 8192
SPO_105:
  s_and_b32 s60, s2, 0xf0
  s_and_b32 s58, s2, 7
  s_lshl_b32 s58, s58, 1
  s_add_u32 s60, s60, s58
  s_bfe_u32 s58, s2, 0x10003
  s_add_u32 s60, s60, s58
  v_lshrrev_b32 v8, 3, v0
  v_mul_u32_u24 v8, 9216, v8
  v_and_b32 v22, 3, v0
  v_lshl_add_u32 v8, v22, 4, v8
  s_mul_i32 s58, s57, 73728
  s_lshl_b32 s59, s60, 6
  s_add_u32 s58, s58, s59
  s_add_u32 s58, s58, 3538944
  s_mov_b32 s61, s58
  s_mov_b64 exec, s[62:63]
  buffer_load_dwordx4 v[104:107], v8, s[28:31], s61 offen nt
  s_mov_b64 exec, s[64:65]
  buffer_load_dwordx4 v[104:107], v8, s[32:35], s61 offen nt
  s_add_u32 s61, s61, 294912
  s_mov_b64 exec, s[62:63]
  buffer_load_dwordx4 v[108:111], v8, s[28:31], s61 offen nt
  s_mov_b64 exec, s[64:65]
  buffer_load_dwordx4 v[108:111], v8, s[32:35], s61 offen nt
  s_add_u32 s61, s61, 294912
  s_mov_b64 exec, s[62:63]
  buffer_load_dwordx4 v[112:115], v8, s[28:31], s61 offen nt
  s_mov_b64 exec, s[64:65]
  buffer_load_dwordx4 v[112:115], v8, s[32:35], s61 offen nt
  s_add_u32 s61, s61, 294912
  s_mov_b64 exec, s[62:63]
  buffer_load_dwordx4 v[116:119], v8, s[28:31], s61 offen nt
  s_mov_b64 exec, s[64:65]
  buffer_load_dwordx4 v[116:119], v8, s[32:35], s61 offen nt
  s_add_u32 s61, s61, 294912
  s_mov_b64 exec, s[62:63]
  buffer_load_dwordx4 v[120:123], v8, s[28:31], s61 offen nt
  s_mov_b64 exec, s[64:65]
  buffer_load_dwordx4 v[120:123], v8, s[32:35], s61 offen nt
  s_add_u32 s61, s61, 294912
  s_mov_b64 exec, s[62:63]
  buffer_load_dwordx4 v[124:127], v8, s[28:31], s61 offen nt
  s_mov_b64 exec, s[64:65]
  buffer_load_dwordx4 v[124:127], v8, s[32:35], s61 offen nt
  s_mov_b64 exec, -1
  v_lshrrev_b32 v8, 3, v0
  v_mul_u32_u24 v8, 1152, v8
  v_and_b32 v22, 7, v0
  v_lshl_add_u32 v8, v22, 4, v8
  s_lshl_b32 s58, s60, 5
  s_lshl_b32 s59, s57, 3
  s_add_u32 s58, s58, s59
  s_mul_i32 s58, s58, 1152
  s_mov_b32 s61, s58
  buffer_load_dwordx4 v[128:131], v8, s[36:39], s61 offen nt
  s_add_u32 s61, s61, 128
  buffer_load_dwordx4 v[132:135], v8, s[36:39], s61 offen nt
  s_add_u32 s61, s61, 128
  buffer_load_dwordx4 v[136:139], v8, s[36:39], s61 offen nt
  s_add_u32 s61, s61, 128
  buffer_load_dwordx4 v[140:143], v8, s[36:39], s61 offen nt
  s_add_u32 s61, s61, 128
  buffer_load_dwordx4 v[144:147], v8, s[36:39], s61 offen nt
  s_add_u32 s61, s61, 128
  buffer_load_dwordx4 v[148:151], v8, s[36:39], s61 offen nt
  s_add_u32 s61, s61, 128
  buffer_load_dwordx4 v[152:155], v8, s[36:39], s61 offen nt
  s_add_u32 s61, s61, 128
  buffer_load_dwordx4 v[156:159], v8, s[36:39], s61 offen nt
  s_add_u32 s61, s61, 128
  buffer_load_dwordx4 v[160:163], v8, s[36:39], s61 offen nt
  v_lshrrev_b32 v1, 1, v18
  v_add_u32 v1, 22016, v1
  v_lshrrev_b32 v22, 4, v0
  v_lshlrev_b32 v22, 4, v22
  v_add_u32 v2, 22016, v22
  v_and_b32 v23, 15, v0
  v_lshl_add_u32 v5, v23, 6, v22
  v_add_u32 v3, 23552, v5
  s_mul_i32 s58, s57, 576
  v_add_u32 v5, s58, v5
  s_lshl_b32 s58, s57, 4
  s_add_u32 s58, s58, 24064
  v_lshl_add_u32 v4, v23, 1, s58
  s_lshl_b32 s58, s57, 3
  s_add_u32 s58, s58, 23296
  v_mov_b32 v8, s58
  v_mov_b32 v6, 0
  v_mov_b32 v7, 0
  s_mul_i32 s74, s2, 2304
  s_add_u32 s74, s74, 393216
  s_waitcnt vmcnt(9)
  v_lshrrev_b32 v24, 3, v0
  v_and_b32 v25, 7, v0
  v_lshlrev_b32 v25, 4, v25
  v_mul_u32_u24 v22, 144, v24
  v_add_u32 v22, v22, v25
  s_mul_i32 s58, s57, 1152
  s_add_u32 s58, s58, 29184
  v_add_u32 v22, s58, v22
  v_add_u32 v23, 41472, v22
  ds_write_b128 v23, v[104:107] offset:13824
  ds_write_b128 v23, v[108:111] offset:18432
  ds_write_b128 v23, v[112:115] offset:23040
  ds_write_b128 v23, v[116:119] offset:27648
  ds_write_b128 v23, v[120:123] offset:32256
  ds_write_b128 v23, v[124:127] offset:36864
  s_mov_b64 exec, 1
  v_mov_b32 v22, 1
  s_waitcnt lgkmcnt(0)
  ds_add_u32 v9, v22 offset:36
  s_mov_b64 exec, -1
  s_mov_b32 s90, 40000
SP_106:
  ds_read_b32 v22, v9 offset:36
  s_waitcnt lgkmcnt(0)
  v_readfirstlane_b32 s91, v22
  s_nop 3
  s_cmp_eq_u32 s91, 4
  s_cbranch_scc1 SPO_107
  s_sleep 2
  s_sub_u32 s90, s90, 1
  s_cbranch_scc0 SP_106
  s_or_b32 s95, s95, 32768
SPO_107:
  v_lshrrev_b32 v22, 4, v0
  v_lshlrev_b32 v22, 3, v22
  v_bfe_u32 v23, v0, 2, 2
  v_add_u32 v22, v22, v23
  v_mul_u32_u24 v22, 144, v22
  v_and_b32 v23, 3, v0
  v_and_b32 v24, 1, v23
  v_lshl_add_u32 v22, v24, 3, v22
  v_lshrrev_b32 v24, 1, v23
  v_lshl_add_u32 v22, v24, 6, v22
  s_lshl_b32 s58, s57, 4
  s_add_u32 s58, s58, 29184
  v_add_u32 v22, s58, v22
  v_add_u32 v23, 41472, v22
  ds_read_b64_tr_b16 v[104:105], v23 offset:13824
  ds_read_b64_tr_b16 v[106:107], v23 offset:14400
  ds_read_b64_tr_b16 v[108:109], v23 offset:18432
  ds_read_b64_tr_b16 v[110:111], v23 offset:19008
  ds_read_b64_tr_b16 v[112:113], v23 offset:23040
  ds_read_b64_tr_b16 v[114:115], v23 offset:23616
  ds_read_b64_tr_b16 v[116:117], v23 offset:27648
  ds_read_b64_tr_b16 v[118:119], v23 offset:28224
  ds_read_b64_tr_b16 v[120:121], v23 offset:32256
  ds_read_b64_tr_b16 v[122:123], v23 offset:32832
  ds_read_b64_tr_b16 v[124:125], v23 offset:36864
  ds_read_b64_tr_b16 v[126:127], v23 offset:37440
  v_lshrrev_b32 v24, 3, v0
  v_and_b32 v25, 7, v0
  v_lshlrev_b32 v25, 4, v25
  v_mul_u32_u24 v6, 1168, v24
  v_add_u32 v6, v6, v25
  s_mul_i32 s58, s57, 9344
  s_add_u32 s58, s58, 112128
  v_add_u32 v6, s58, v6
  v_lshrrev_b32 v22, 4, v0
  v_lshlrev_b32 v22, 3, v22
  v_bfe_u32 v23, v0, 2, 2
  v_add_u32 v22, v22, v23
  v_mul_u32_u24 v22, 1168, v22
  v_and_b32 v23, 3, v0
  v_lshl_add_u32 v22, v23, 3, v22
  s_mul_i32 s58, s57, 288
  s_add_u32 s58, s58, 112128
  v_add_u32 v22, s58, v22
  v_mov_b32 v7, v22
  s_mov_b32 s58, 327680
  s_mov_b32 s59, 332288
  s_mov_b32 s72, 336896
  s_mov_b32 s73, 341504
  v_lshrrev_b32 v23, 2, v0
  s_mul_i32 s59, s57, 9
  v_add_u32 v23, s59, v23
  v_lshlrev_b32 v23, 10, v23
  v_and_b32 v22, 3, v0
  v_lshl_add_u32 v23, v22, 4, v23
  s_mov_b32 s90, 40000
SP_108:
  ds_read_b32 v22, v9 offset:12
  s_waitcnt lgkmcnt(0)
  v_readfirstlane_b32 s91, v22
  s_nop 3
  s_cmp_eq_u32 s91, 8
  s_cbranch_scc1 SPO_109
  s_sleep 2
  s_sub_u32 s90, s90, 1
  s_cbranch_scc0 SP_108
  s_or_b32 s95, s95, 4096
SPO_109:
  s_mov_b64 exec, s[66:67]
  buffer_load_dwordx4 v[24:27], v23, s[16:19], s58 offen offset:0 sc1
  buffer_load_dwordx4 v[28:31], v23, s[16:19], s58 offen offset:128 sc1
  buffer_load_dwordx4 v[32:35], v23, s[16:19], s58 offen offset:256 sc1
  buffer_load_dwordx4 v[36:39], v23, s[16:19], s58 offen offset:384 sc1
  buffer_load_dwordx4 v[40:43], v23, s[16:19], s58 offen offset:512 sc1
  buffer_load_dwordx4 v[44:47], v23, s[16:19], s58 offen offset:640 sc1
  buffer_load_dwordx4 v[48:51], v23, s[16:19], s58 offen offset:768 sc1
  buffer_load_dwordx4 v[52:55], v23, s[16:19], s58 offen offset:896 sc1
  s_mov_b64 exec, -1
  s_waitcnt vmcnt(8)
  ds_write_b128 v6, v[128:131] offset:0
  ds_write_b128 v6, v[132:135] offset:128
  ds_write_b128 v6, v[136:139] offset:256
  ds_write_b128 v6, v[140:143] offset:384
  ds_write_b128 v6, v[144:147] offset:512
  ds_write_b128 v6, v[148:151] offset:640
  ds_write_b128 v6, v[152:155] offset:768
  ds_write_b128 v6, v[156:159] offset:896
  ds_write_b128 v6, v[160:163] offset:1024
  s_mov_b64 exec, 1
  v_mov_b32 v22, 1
  s_waitcnt lgkmcnt(0)
  ds_add_u32 v9, v22 offset:16
  s_mov_b64 exec, -1
  s_mov_b32 s90, 40000
SP_113:
  ds_read_b32 v22, v9 offset:16
  s_waitcnt lgkmcnt(0)
  v_readfirstlane_b32 s91, v22
  s_nop 3
  s_cmp_eq_u32 s91, 4
  s_cbranch_scc1 SPO_114
  s_sleep 2
  s_sub_u32 s90, s90, 1
  s_cbranch_scc0 SP_113
  s_or_b32 s95, s95, 32768
SPO_114:
  ds_read_b64_tr_b16 v[128:129], v7 offset:0
  ds_read_b64_tr_b16 v[130:131], v7 offset:4672
  ds_read_b64_tr_b16 v[132:133], v7 offset:32
  ds_read_b64_tr_b16 v[134:135], v7 offset:4704
  ds_read_b64_tr_b16 v[136:137], v7 offset:64
  ds_read_b64_tr_b16 v[138:139], v7 offset:4736
  ds_read_b64_tr_b16 v[140:141], v7 offset:96
  ds_read_b64_tr_b16 v[142:143], v7 offset:4768
  ds_read_b64_tr_b16 v[144:145], v7 offset:128
  ds_read_b64_tr_b16 v[146:147], v7 offset:4800
  ds_read_b64_tr_b16 v[148:149], v7 offset:160
  ds_read_b64_tr_b16 v[150:151], v7 offset:4832
  ds_read_b64_tr_b16 v[152:153], v7 offset:192
  ds_read_b64_tr_b16 v[154:155], v7 offset:4864
  ds_read_b64_tr_b16 v[156:157], v7 offset:224
  ds_read_b64_tr_b16 v[158:159], v7 offset:4896
  ds_read_b64_tr_b16 v[160:161], v7 offset:256
  ds_read_b64_tr_b16 v[162:163], v7 offset:4928
  v_mov_b32 v6, 0
  v_mov_b32 v7, 0
  s_mov_b64 exec, s[66:67]
  s_mov_b32 s90, 8000
  s_branch PLC_112
PL_110:
  buffer_load_dwordx4 v[24:27], v23, s[16:19], s58 offen offset:0 sc1
  buffer_load_dwordx4 v[28:31], v23, s[16:19], s58 offen offset:128 sc1
  buffer_load_dwordx4 v[32:35], v23, s[16:19], s58 offen offset:256 sc1
  buffer_load_dwordx4 v[36:39], v23, s[16:19], s58 offen offset:384 sc1
  buffer_load_dwordx4 v[40:43], v23, s[16:19], s58 offen offset:512 sc1
  buffer_load_dwordx4 v[44:47], v23, s[16:19], s58 offen offset:640 sc1
  buffer_load_dwordx4 v[48:51], v23, s[16:19], s58 offen offset:768 sc1
  buffer_load_dwordx4 v[52:55], v23, s[16:19], s58 offen offset:896 sc1
PLC_112:
  s_waitcnt vmcnt(0)
  v_min_u32 v22, v24, v25
  v_min3_u32 v22, v22, v26, v27
  v_min3_u32 v22, v22, v28, v29
  v_min3_u32 v22, v22, v30, v31
  v_min3_u32 v22, v22, v32, v33
  v_min3_u32 v22, v22, v34, v35
  v_min3_u32 v22, v22, v36, v37
  v_min3_u32 v22, v22, v38, v39
  v_min3_u32 v22, v22, v40, v41
  v_min3_u32 v22, v22, v42, v43
  v_min3_u32 v22, v22, v44, v45
  v_min3_u32 v22, v22, v46, v47
  v_min3_u32 v22, v22, v48, v49
  v_min3_u32 v22, v22, v50, v51
  v_min3_u32 v22, v22, v52, v53
  v_min3_u32 v22, v22, v54, v55
  v_cmp_ne_u32 vcc, 0, v22
  s_nop 3
  s_cmp_eq_u64 vcc, s[66:67]
  s_cbranch_scc1 PLO_111
  s_sleep 1
  s_sub_u32 s90, s90, 1
  s_cbranch_scc0 PL_110
  s_or_b32 s95, s95, 1024
PLO_111:
  v_pk_add_f32 v[24:25], v[24:25], v[40:41]
  v_pk_add_f32 v[26:27], v[26:27], v[42:43]
  v_pk_add_f32 v[28:29], v[28:29], v[44:45]
  v_pk_add_f32 v[30:31], v[30:31], v[46:47]
  v_pk_add_f32 v[32:33], v[32:33], v[48:49]
  v_pk_add_f32 v[34:35], v[34:35], v[50:51]
  v_pk_add_f32 v[36:37], v[36:37], v[52:53]
  v_pk_add_f32 v[38:39], v[38:39], v[54:55]
  v_pk_add_f32 v[24:25], v[24:25], v[32:33]
  v_pk_add_f32 v[26:27], v[26:27], v[34:35]
  v_pk_add_f32 v[28:29], v[28:29], v[36:37]
  v_pk_add_f32 v[30:31], v[30:31], v[38:39]
  v_pk_add_f32 v[24:25], v[24:25], v[28:29]
  v_pk_add_f32 v[26:27], v[26:27], v[30:31]
  v_cvt_pk_bf16_f32 v24, 0, v24
  v_cvt_pk_bf16_f32 v25, 0, v25
  v_cvt_pk_bf16_f32 v26, 0, v26
  v_cvt_pk_bf16_f32 v27, 0, v27
  v_pk_mul_f32 v[24:25], v[14:15], v[24:25]
  v_pk_mul_f32 v[26:27], v[16:17], v[26:27]
  v_cvt_pk_bf16_f32 v24, 0, v24
  v_cvt_pk_bf16_f32 v25, 0, v25
  v_cvt_pk_bf16_f32 v26, 0, v26
  v_cvt_pk_bf16_f32 v27, 0, v27
  v_pk_add_f32 v[10:11], v[10:11], v[24:25]
  v_pk_add_f32 v[12:13], v[12:13], v[26:27]
  v_cvt_pk_bf16_f32 v10, 0, v10
  v_cvt_pk_bf16_f32 v11, 0, v11
  v_cvt_pk_bf16_f32 v12, 0, v12
  v_cvt_pk_bf16_f32 v13, 0, v13
  v_pk_add_f32 v[24:25], v[10:11], v[12:13]
  v_mul_f32 v7, v10, v10
  v_add_f32 v6, v24, v25
  v_fmac_f32 v7, v11, v11
  v_fmac_f32 v7, v12, v12
  v_fmac_f32 v7, v13, v13
  ds_write_b128 v18, v[10:13] offset:17408
  s_mov_b64 exec, -1
  v_add_f32_dpp v6, v6, v6 quad_perm:[1,0,3,2] row_mask:0xf bank_mask:0xf
  v_add_f32_dpp v7, v7, v7 quad_perm:[1,0,3,2] row_mask:0xf bank_mask:0xf
  s_nop 0
  v_add_f32_dpp v6, v6, v6 quad_perm:[2,3,0,1] row_mask:0xf bank_mask:0xf
  v_add_f32_dpp v7, v7, v7 quad_perm:[2,3,0,1] row_mask:0xf bank_mask:0xf
  s_nop 0
  v_add_f32_dpp v6, v6, v6 row_half_mirror row_mask:0xf bank_mask:0xf
  v_add_f32_dpp v7, v7, v7 row_half_mirror row_mask:0xf bank_mask:0xf
  s_nop 0
  v_add_f32_dpp v6, v6, v6 row_mirror row_mask:0xf bank_mask:0xf
  v_add_f32_dpp v7, v7, v7 row_mirror row_mask:0xf bank_mask:0xf
  v_mov_b32 v28, v6
  v_mov_b32 v29, v7
  s_nop 0
  v_permlane16_swap_b32 v6, v28
  v_permlane16_swap_b32 v7, v29
  v_add_f32 v6, v6, v28
  v_add_f32 v7, v7, v29
  v_mov_b32 v28, v6
  v_mov_b32 v29, v7
  s_nop 0
  v_permlane32_swap_b32 v6, v28
  v_permlane32_swap_b32 v7, v29
  v_add_f32 v6, v6, v28
  v_add_f32 v7, v7, v29
  s_mov_b64 exec, 1
  ds_write_b64 v8, v[6:7]
  s_mov_b64 exec, -1
  s_waitcnt lgkmcnt(0)
  s_barrier
  ds_read_b128 v[24:27], v9 offset:23296
  ds_read_b128 v[28:31], v9 offset:23312
  v_and_b32 v33, s94, v20
  v_and_b32 v35, s94, v21
  v_lshlrev_b32 v32, 16, v20
  v_lshlrev_b32 v34, 16, v21
  s_waitcnt lgkmcnt(0)
  v_pk_add_f32 v[24:25], v[24:25], v[26:27]
  v_pk_add_f32 v[28:29], v[28:29], v[30:31]
  v_pk_add_f32 v[24:25], v[24:25], v[28:29]
  v_mul_f32 v22, 0x3ae38e39, v24
  v_mul_f32 v23, 0x3ae38e39, v25
  v_fma_f32 v23, -v22, v22, v23
  v_cvt_pk_bf16_f32 v22, 0, v22
  v_cvt_pk_bf16_f32 v23, 0, v23
  v_add_f32 v23, 0x3727c5ac, v23
  v_cvt_pk_bf16_f32 v23, 0, v23
  v_sqrt_f32 v23, v23
  v_sub_f32 v24, v10, v22
  v_sub_f32 v25, v11, v22
  v_sub_f32 v26, v12, v22
  v_sub_f32 v27, v13, v22
  v_cvt_pk_bf16_f32 v23, 0, v23
  v_cvt_pk_bf16_f32 v24, 0, v24
  v_cvt_pk_bf16_f32 v25, 0, v25
  v_cvt_pk_bf16_f32 v26, 0, v26
  v_cvt_pk_bf16_f32 v27, 0, v27
  v_rcp_f32 v23, v23
  s_nop 0
  v_mul_f32 v24, v23, v24
  v_mul_f32 v25, v23, v25
  v_mul_f32 v26, v23, v26
  v_mul_f32 v27, v23, v27
  v_cvt_pk_bf16_f32 v24, 0, v24
  v_cvt_pk_bf16_f32 v25, 0, v25
  v_cvt_pk_bf16_f32 v26, 0, v26
  v_cvt_pk_bf16_f32 v27, 0, v27
  v_pk_mul_f32 v[24:25], v[24:25], v[164:165]
  v_pk_mul_f32 v[26:27], v[26:27], v[166:167]
  v_cvt_pk_bf16_f32 v24, 0, v24
  v_cvt_pk_bf16_f32 v25, 0, v25
  v_cvt_pk_bf16_f32 v26, 0, v26
  v_cvt_pk_bf16_f32 v27, 0, v27
  v_pk_add_f32 v[24:25], v[24:25], v[32:33]
  v_pk_add_f32 v[26:27], v[26:27], v[34:35]
  v_cvt_pk_bf16_f32 v24, v24, v25
  v_cvt_pk_bf16_f32 v25, v26, v27
  s_mov_b64 exec, s[66:67]
  ds_write_b64 v1, v[24:25]
  s_mov_b64 exec, -1
  s_waitcnt lgkmcnt(0)
  s_barrier
  ds_read_b128 v[24:27], v2 offset:0
  ds_read_b128 v[28:31], v2 offset:64
  ds_read_b128 v[32:35], v2 offset:128
  ds_read_b128 v[36:39], v2 offset:192
  ds_read_b128 v[40:43], v2 offset:256
  ds_read_b128 v[44:47], v2 offset:320
  ds_read_b128 v[48:51], v2 offset:384
  ds_read_b128 v[52:55], v2 offset:448
  s_waitcnt lgkmcnt(7)
  v_mfma_f32_16x16x32_bf16 v[10:13], v[24:27], v[56:59], 0
  ds_read_b128 v[24:27], v2 offset:512
  s_waitcnt lgkmcnt(7)
  v_mfma_f32_16x16x32_bf16 v[14:17], v[28:31], v[60:63], 0
  ds_read_b128 v[28:31], v2 offset:576
  s_waitcnt lgkmcnt(7)
  v_mfma_f32_16x16x32_bf16 v[10:13], v[32:35], v[64:67], v[10:13]
  ds_read_b128 v[32:35], v2 offset:640
  s_waitcnt lgkmcnt(7)
  v_mfma_f32_16x16x32_bf16 v[14:17], v[36:39], v[68:71], v[14:17]
  ds_read_b128 v[36:39], v2 offset:704
  s_waitcnt lgkmcnt(7)
  v_mfma_f32_16x16x32_bf16 v[10:13], v[40:43], v[72:75], v[10:13]
  ds_read_b128 v[40:43], v2 offset:768
  s_waitcnt lgkmcnt(7)
  v_mfma_f32_16x16x32_bf16 v[14:17], v[44:47], v[76:79], v[14:17]
  ds_read_b128 v[44:47], v2 offset:832
  s_waitcnt lgkmcnt(7)
  v_mfma_f32_16x16x32_bf16 v[10:13], v[48:51], v[80:83], v[10:13]
  ds_read_b128 v[48:51], v2 offset:896
  s_waitcnt lgkmcnt(7)
  v_mfma_f32_16x16x32_bf16 v[14:17], v[52:55], v[84:87], v[14:17]
  ds_read_b128 v[52:55], v2 offset:960
  s_waitcnt lgkmcnt(7)
  v_mfma_f32_16x16x32_bf16 v[10:13], v[24:27], v[88:91], v[10:13]
  ds_read_b128 v[24:27], v2 offset:1024
  s_waitcnt lgkmcnt(7)
  v_mfma_f32_16x16x32_bf16 v[14:17], v[28:31], v[92:95], v[14:17]
  ds_read_b128 v[28:31], v2 offset:1088
  s_waitcnt lgkmcnt(7)
  v_mfma_f32_16x16x32_bf16 v[10:13], v[32:35], v[96:99], v[10:13]
  s_waitcnt lgkmcnt(6)
  v_mfma_f32_16x16x32_bf16 v[14:17], v[36:39], v[100:103], v[14:17]
  s_waitcnt lgkmcnt(5)
  v_mfma_f32_16x16x32_bf16 v[10:13], v[40:43], v[104:107], v[10:13]
  s_waitcnt lgkmcnt(4)
  v_mfma_f32_16x16x32_bf16 v[14:17], v[44:47], v[108:111], v[14:17]
  s_waitcnt lgkmcnt(3)
  v_mfma_f32_16x16x32_bf16 v[10:13], v[48:51], v[112:115], v[10:13]
  s_waitcnt lgkmcnt(2)
  v_mfma_f32_16x16x32_bf16 v[14:17], v[52:55], v[116:119], v[14:17]
  s_waitcnt lgkmcnt(1)
  v_mfma_f32_16x16x32_bf16 v[10:13], v[24:27], v[120:123], v[10:13]
  s_waitcnt lgkmcnt(0)
  v_mfma_f32_16x16x32_bf16 v[14:17], v[28:31], v[124:127], v[14:17]
  s_nop 7
  v_add_f32 v24, v10, v14
  v_cvt_pk_bf16_f32 v24, 0, v24
  s_nop 1
  v_mov_b32_dpp v25, v24 row_ror:8 row_mask:0xf bank_mask:0xf
  v_mul_f32 v26, v24, v24
  v_mov_b32 v27, 0xc0135761
  v_fmac_f32 v27, 0xbdd2d3e8, v26
  v_mul_f32 v26, v24, v27
  v_exp_f32 v26, v26
  s_nop 0
  v_add_f32 v26, 1.0, v26
  v_rcp_f32 v26, v26
  s_nop 0
  v_mul_f32 v24, v24, v26
  v_cvt_pk_bf16_f32 v24, 0, v24
  v_mul_f32 v24, v24, v25
  v_cvt_pk_bf16_f32 v24, v24, v24
  s_mov_b64 exec, 0xff
  ds_write_b16 v4, v24
  s_mov_b64 exec, -1
  s_waitcnt lgkmcnt(0)
  s_barrier
  ds_read_b128 v[24:27], v3 offset:512
  ds_read_b128 v[28:31], v3 offset:448
  ds_read_b128 v[32:35], v3 offset:384
  ds_read_b128 v[36:39], v3 offset:320
  ds_read_b128 v[40:43], v3 offset:256
  ds_read_b128 v[44:47], v3 offset:192
  ds_read_b128 v[48:51], v3 offset:128
  ds_read_b128 v[52:55], v3 offset:64
  ds_read_b128 v[56:59], v3 offset:0
  s_waitcnt lgkmcnt(8)
  v_mfma_f32_16x16x32_bf16 v[10:13], v[128:131], v[24:27], 0
  s_waitcnt lgkmcnt(7)
  v_mfma_f32_16x16x32_bf16 v[14:17], v[132:135], v[28:31], 0
  s_waitcnt lgkmcnt(6)
  v_mfma_f32_16x16x32_bf16 v[10:13], v[136:139], v[32:35], v[10:13]
  s_waitcnt lgkmcnt(5)
  v_mfma_f32_16x16x32_bf16 v[14:17], v[140:143], v[36:39], v[14:17]
  s_waitcnt lgkmcnt(4)
  v_mfma_f32_16x16x32_bf16 v[10:13], v[144:147], v[40:43], v[10:13]
  s_waitcnt lgkmcnt(3)
  v_mfma_f32_16x16x32_bf16 v[14:17], v[148:151], v[44:47], v[14:17]
  s_waitcnt lgkmcnt(2)
  v_mfma_f32_16x16x32_bf16 v[10:13], v[152:155], v[48:51], v[10:13]
  s_waitcnt lgkmcnt(1)
  v_mfma_f32_16x16x32_bf16 v[14:17], v[156:159], v[52:55], v[14:17]
  s_waitcnt lgkmcnt(0)
  v_mfma_f32_16x16x32_bf16 v[10:13], v[160:163], v[56:59], v[10:13]
  s_nop 7
  v_pk_add_f32 v[10:11], v[10:11], v[14:15]
  v_pk_add_f32 v[12:13], v[12:13], v[16:17]
  v_or_b32 v10, 1, v10
  v_or_b32 v11, 1, v11
  v_or_b32 v12, 1, v12
  v_or_b32 v13, 1, v13
  s_mov_b32 exec_lo, 0x01ff01ff
  s_mov_b32 exec_hi, 0x01ff01ff
  buffer_store_dwordx4 v[10:13], v5, s[16:19], s74 offen sc1
  s_mov_b64 exec, -1
  s_cmp_lt_u32 s2, 18
  s_cbranch_scc0 L_AUX_END
  s_cmp_lt_u32 s57, 2
  s_cbranch_scc0 L_AUX_END
  s_lshl_b32 s60, s2, 1
  s_add_u32 s60, s60, s57
  v_lshrrev_b32 v22, 2, v0
  v_mul_u32_u24 v22, 2304, v22
  v_and_b32 v23, 3, v0
  v_lshl_add_u32 v22, v23, 4, v22
  s_lshl_b32 s58, s60, 6
  s_add_u32 s58, s58, 393216
  s_add_u32 s72, s58, 0
  s_add_u32 s73, s58, 36864
  s_add_u32 s74, s58, 73728
  s_add_u32 s75, s58, 110592
  s_add_u32 s76, s58, 147456
  s_add_u32 s77, s58, 184320
  s_add_u32 s78, s58, 221184
  s_add_u32 s79, s58, 258048
  s_add_u32 s80, s58, 294912
  s_lshl_b32 s59, s60, 6
  v_lshlrev_b32 v21, 4, v23
  v_add_u32 v21, s59, v21
  ds_read_b128 v[10:13], v21 offset:17408
  ds_read_b128 v[14:17], v21 offset:19712
  s_mov_b32 s90, 8000
PL_115:
  buffer_load_dwordx4 v[56:59], v22, s[16:19], s72 offen offset:0 sc1
  buffer_load_dwordx4 v[60:63], v22, s[16:19], s73 offen offset:0 sc1
  buffer_load_dwordx4 v[64:67], v22, s[16:19], s74 offen offset:0 sc1
  buffer_load_dwordx4 v[68:71], v22, s[16:19], s75 offen offset:0 sc1
  buffer_load_dwordx4 v[72:75], v22, s[16:19], s76 offen offset:0 sc1
  buffer_load_dwordx4 v[76:79], v22, s[16:19], s77 offen offset:0 sc1
  buffer_load_dwordx4 v[80:83], v22, s[16:19], s78 offen offset:0 sc1
  buffer_load_dwordx4 v[84:87], v22, s[16:19], s79 offen offset:0 sc1
  buffer_load_dwordx4 v[88:91], v22, s[16:19], s80 offen offset:0 sc1
  s_waitcnt vmcnt(0)
  v_min_u32 v24, v56, v57
  v_min3_u32 v24, v24, v58, v59
  v_min3_u32 v24, v24, v60, v61
  v_min3_u32 v24, v24, v62, v63
  v_min3_u32 v24, v24, v64, v65
  v_min3_u32 v24, v24, v66, v67
  v_min3_u32 v24, v24, v68, v69
  v_min3_u32 v24, v24, v70, v71
  v_min3_u32 v24, v24, v72, v73
  v_min3_u32 v24, v24, v74, v75
  v_min3_u32 v24, v24, v76, v77
  v_min3_u32 v24, v24, v78, v79
  v_min3_u32 v24, v24, v80, v81
  v_min3_u32 v24, v24, v82, v83
  v_min3_u32 v24, v24, v84, v85
  v_min3_u32 v24, v24, v86, v87
  v_min3_u32 v24, v24, v88, v89
  v_min3_u32 v24, v24, v90, v91
  v_cmp_ne_u32 vcc, 0, v24
  s_nop 3
  s_cmp_eq_u64 vcc, -1
  s_cbranch_scc1 PLO_116
  s_sleep 1
  s_sub_u32 s90, s90, 1
  s_cbranch_scc0 PL_115
  s_or_b32 s95, s95, 2048
PLO_116:
  v_add_f32 v56, v56, v60
  v_add_f32 v57, v57, v61
  v_add_f32 v58, v58, v62
  v_add_f32 v59, v59, v63
  v_add_f32 v56, v56, v64
  v_add_f32 v57, v57, v65
  v_add_f32 v58, v58, v66
  v_add_f32 v59, v59, v67
  v_add_f32 v56, v56, v68
  v_add_f32 v57, v57, v69
  v_add_f32 v58, v58, v70
  v_add_f32 v59, v59, v71
  v_add_f32 v56, v56, v72
  v_add_f32 v57, v57, v73
  v_add_f32 v58, v58, v74
  v_add_f32 v59, v59, v75
  v_add_f32 v56, v56, v76
  v_add_f32 v57, v57, v77
  v_add_f32 v58, v58, v78
  v_add_f32 v59, v59, v79
  v_add_f32 v56, v56, v80
  v_add_f32 v57, v57, v81
  v_add_f32 v58, v58, v82
  v_add_f32 v59, v59, v83
  v_add_f32 v56, v56, v84
  v_add_f32 v57, v57, v85
  v_add_f32 v58, v58, v86
  v_add_f32 v59, v59, v87
  v_add_f32 v56, v56, v88
  v_add_f32 v57, v57, v89
  v_add_f32 v58, v58, v90
  v_add_f32 v59, v59, v91
  v_add_f32_dpp v56, v56, v56 row_ror:4 row_mask:0xf bank_mask:0xf
  v_add_f32_dpp v57, v57, v57 row_ror:4 row_mask:0xf bank_mask:0xf
  v_add_f32_dpp v58, v58, v58 row_ror:4 row_mask:0xf bank_mask:0xf
  v_add_f32_dpp v59, v59, v59 row_ror:4 row_mask:0xf bank_mask:0xf
  v_add_f32_dpp v56, v56, v56 row_ror:8 row_mask:0xf bank_mask:0xf
  v_add_f32_dpp v57, v57, v57 row_ror:8 row_mask:0xf bank_mask:0xf
  v_add_f32_dpp v58, v58, v58 row_ror:8 row_mask:0xf bank_mask:0xf
  v_add_f32_dpp v59, v59, v59 row_ror:8 row_mask:0xf bank_mask:0xf
  v_mov_b32 v60, v56
  v_mov_b32 v61, v57
  v_mov_b32 v62, v58
  v_mov_b32 v63, v59
  v_permlane16_swap_b32 v56, v60
  v_permlane16_swap_b32 v57, v61
  v_permlane16_swap_b32 v58, v62
  v_permlane16_swap_b32 v59, v63
  v_add_f32 v56, v56, v60
  v_add_f32 v57, v57, v61
  v_add_f32 v58, v58, v62
  v_add_f32 v59, v59, v63
  v_mov_b32 v60, v56
  v_mov_b32 v61, v57
  v_mov_b32 v62, v58
  v_mov_b32 v63, v59
  v_permlane32_swap_b32 v56, v60
  v_permlane32_swap_b32 v57, v61
  v_permlane32_swap_b32 v58, v62
  v_permlane32_swap_b32 v59, v63
  v_add_f32 v56, v56, v60
  v_add_f32 v57, v57, v61
  v_add_f32 v58, v58, v62
  v_add_f32 v59, v59, v63
  s_waitcnt lgkmcnt(0)
  v_cvt_pk_bf16_f32 v56, 0, v56
  v_cvt_pk_bf16_f32 v57, 0, v57
  v_cvt_pk_bf16_f32 v58, 0, v58
  v_cvt_pk_bf16_f32 v59, 0, v59
  v_mul_f32 v56, v14, v56
  v_mul_f32 v57, v15, v57
  v_mul_f32 v58, v16, v58
  v_mul_f32 v59, v17, v59
  v_cvt_pk_bf16_f32 v56, 0, v56
  v_cvt_pk_bf16_f32 v57, 0, v57
  v_cvt_pk_bf16_f32 v58, 0, v58
  v_cvt_pk_bf16_f32 v59, 0, v59
  v_add_f32 v56, v10, v56
  v_add_f32 v57, v11, v57
  v_add_f32 v58, v12, v58
  v_add_f32 v59, v13, v59
  v_cvt_pk_bf16_f32 v24, v56, v57
  v_cvt_pk_bf16_f32 v25, v58, v59
  v_lshrrev_b32 v21, 1, v21
  s_mov_b64 exec, 0xf
  buffer_store_dwordx2 v[24:25], v21, s[52:55], 0 offen
  s_cmp_lg_u32 s60, 0
  s_cbranch_scc1 L_F_NOEP
  s_mov_b64 exec, 1
  v_mov_b32 v23, s56
  buffer_store_dword v23, v9, s[16:19], 0 offen sc1
L_F_NOEP:
  s_mov_b64 exec, -1
  s_branch L_AUX_END
L_G_WO:
  s_sub_u32 s60, s2, 144
  s_cmp_lt_u32 s2, 208
  s_cbranch_scc1 WOI_118
  s_sub_u32 s60, s2, 180
WOI_118:
  s_lshr_b32 s60, s60, 3
  s_and_b32 s58, s2, 7
  s_mul_i32 s58, s58, 9
  s_add_u32 s60, s60, s58
  s_mul_i32 s70, s60, 57
  s_lshr_b32 s70, s70, 9
  s_mul_i32 s71, s70, 9
  s_sub_u32 s71, s60, s71
  s_lshl_b32 s58, s70, 1
  s_lshr_b32 s59, s57, 1
  s_add_u32 s58, s58, s59
  s_lshl_b32 s58, s58, 14
  s_and_b32 s59, s57, 1
  s_lshl_b32 s59, s59, 9
  s_add_u32 s58, s58, s59
  s_add_u32 s58, s58, 65536
  v_lshrrev_b32 v22, 5, v0
  v_lshlrev_b32 v22, 10, v22
  v_and_b32 v23, 31, v0
  v_lshl_add_u32 v22, v23, 4, v22
  s_lshl_b32 s59, s57, 8
  s_add_u32 s59, s59, 22016
  v_lshl_add_u32 v1, v23, 3, s59
  v_lshrrev_b32 v3, 4, v0
  v_lshlrev_b32 v3, 4, v3
  v_add_u32 v2, 22016, v3
  s_lshl_b32 s59, s57, 10
  v_add_u32 v3, s59, v3
  s_lshl_b32 s74, s70, 7
  s_lshl_b32 s59, s71, 12
  s_add_u32 s74, s74, s59
  s_add_u32 s74, s74, 327680
  s_add_u32 s59, s58, 4096
  s_add_u32 s72, s58, 8192
  s_add_u32 s73, s58, 12288
  s_mov_b32 s90, 40000
SP_119:
  ds_read_b32 v24, v9 offset:12
  s_waitcnt lgkmcnt(0)
  v_readfirstlane_b32 s91, v24
  s_nop 3
  s_cmp_eq_u32 s91, 8
  s_cbranch_scc1 SPO_120
  s_sleep 2
  s_sub_u32 s90, s90, 1
  s_cbranch_scc0 SP_119
  s_or_b32 s95, s95, 4096
SPO_120:
  s_mov_b32 s90, 8000
PL_121:
  buffer_load_dwordx4 v[120:123], v22, s[16:19], s58 offen offset:0 sc1
  buffer_load_dwordx4 v[124:127], v22, s[16:19], s58 offen offset:2048 sc1
  buffer_load_dwordx4 v[128:131], v22, s[16:19], s59 offen offset:0 sc1
  buffer_load_dwordx4 v[132:135], v22, s[16:19], s59 offen offset:2048 sc1
  buffer_load_dwordx4 v[136:139], v22, s[16:19], s72 offen offset:0 sc1
  buffer_load_dwordx4 v[140:143], v22, s[16:19], s72 offen offset:2048 sc1
  buffer_load_dwordx4 v[144:147], v22, s[16:19], s73 offen offset:0 sc1
  buffer_load_dwordx4 v[148:151], v22, s[16:19], s73 offen offset:2048 sc1
  s_waitcnt vmcnt(0)
  v_min_u32 v24, v120, v121
  v_min3_u32 v24, v24, v122, v123
  v_min3_u32 v24, v24, v124, v125
  v_min3_u32 v24, v24, v126, v127
  v_min3_u32 v24, v24, v128, v129
  v_min3_u32 v24, v24, v130, v131
  v_min3_u32 v24, v24, v132, v133
  v_min3_u32 v24, v24, v134, v135
  v_min3_u32 v24, v24, v136, v137
  v_min3_u32 v24, v24, v138, v139
  v_min3_u32 v24, v24, v140, v141
  v_min3_u32 v24, v24, v142, v143
  v_min3_u32 v24, v24, v144, v145
  v_min3_u32 v24, v24, v146, v147
  v_min3_u32 v24, v24, v148, v149
  v_min3_u32 v24, v24, v150, v151
  v_cmp_ne_u32 vcc, 0, v24
  s_nop 3
  s_cmp_eq_u64 vcc, -1
  s_cbranch_scc1 PLO_122
  s_sleep 1
  s_sub_u32 s90, s90, 1
  s_cbranch_scc0 PL_121
  s_or_b32 s95, s95, 256
PLO_122:
  v_pk_add_f32 v[120:121], v[120:121], v[136:137]
  v_pk_add_f32 v[122:123], v[122:123], v[138:139]
  v_pk_add_f32 v[124:125], v[124:125], v[140:141]
  v_pk_add_f32 v[126:127], v[126:127], v[142:143]
  v_pk_add_f32 v[128:129], v[128:129], v[144:145]
  v_pk_add_f32 v[130:131], v[130:131], v[146:147]
  v_pk_add_f32 v[132:133], v[132:133], v[148:149]
  v_pk_add_f32 v[134:135], v[134:135], v[150:151]
  v_pk_add_f32 v[120:121], v[120:121], v[128:129]
  v_pk_add_f32 v[122:123], v[122:123], v[130:131]
  v_pk_add_f32 v[124:125], v[124:125], v[132:133]
  v_pk_add_f32 v[126:127], v[126:127], v[134:135]
  v_pk_add_f32 v[120:121], v[120:121], v[124:125]
  v_pk_add_f32 v[122:123], v[122:123], v[126:127]
  v_mov_b32 v124, v120
  v_mov_b32 v125, v121
  v_mov_b32 v126, v122
  v_mov_b32 v127, v123
  v_permlane32_swap_b32 v120, v124
  v_permlane32_swap_b32 v121, v125
  v_permlane32_swap_b32 v122, v126
  v_permlane32_swap_b32 v123, v127
  v_add_f32 v120, v120, v124
  v_add_f32 v121, v121, v125
  v_add_f32 v122, v122, v126
  v_add_f32 v123, v123, v127
  v_cvt_pk_bf16_f32 v24, v120, v121
  v_cvt_pk_bf16_f32 v25, v122, v123
  ds_write_b64 v1, v[24:25]
  s_waitcnt lgkmcnt(0)
  s_barrier
  ds_read_b128 v[24:27], v2 offset:0
  ds_read_b128 v[28:31], v2 offset:64
  ds_read_b128 v[32:35], v2 offset:128
  ds_read_b128 v[36:39], v2 offset:192
  ds_read_b128 v[40:43], v2 offset:256
  ds_read_b128 v[44:47], v2 offset:320
  ds_read_b128 v[48:51], v2 offset:384
  ds_read_b128 v[52:55], v2 offset:448
  ds_read_b128 v[120:123], v2 offset:512
  ds_read_b128 v[124:127], v2 offset:576
  ds_read_b128 v[128:131], v2 offset:640
  ds_read_b128 v[132:135], v2 offset:704
  ds_read_b128 v[136:139], v2 offset:768
  ds_read_b128 v[140:143], v2 offset:832
  ds_read_b128 v[144:147], v2 offset:896
  ds_read_b128 v[148:151], v2 offset:960
  s_waitcnt lgkmcnt(15)
  v_mfma_f32_16x16x32_bf16 v[10:13], v[56:59], v[24:27], 0
  s_waitcnt lgkmcnt(14)
  v_mfma_f32_16x16x32_bf16 v[14:17], v[60:63], v[28:31], 0
  s_waitcnt lgkmcnt(13)
  v_mfma_f32_16x16x32_bf16 v[10:13], v[64:67], v[32:35], v[10:13]
  s_waitcnt lgkmcnt(12)
  v_mfma_f32_16x16x32_bf16 v[14:17], v[68:71], v[36:39], v[14:17]
  s_waitcnt lgkmcnt(11)
  v_mfma_f32_16x16x32_bf16 v[10:13], v[72:75], v[40:43], v[10:13]
  s_waitcnt lgkmcnt(10)
  v_mfma_f32_16x16x32_bf16 v[14:17], v[76:79], v[44:47], v[14:17]
  s_waitcnt lgkmcnt(9)
  v_mfma_f32_16x16x32_bf16 v[10:13], v[80:83], v[48:51], v[10:13]
  s_waitcnt lgkmcnt(8)
  v_mfma_f32_16x16x32_bf16 v[14:17], v[84:87], v[52:55], v[14:17]
  s_waitcnt lgkmcnt(7)
  v_mfma_f32_16x16x32_bf16 v[10:13], v[88:91], v[120:123], v[10:13]
  s_waitcnt lgkmcnt(6)
  v_mfma_f32_16x16x32_bf16 v[14:17], v[92:95], v[124:127], v[14:17]
  s_waitcnt lgkmcnt(5)
  v_mfma_f32_16x16x32_bf16 v[10:13], v[96:99], v[128:131], v[10:13]
  s_waitcnt lgkmcnt(4)
  v_mfma_f32_16x16x32_bf16 v[14:17], v[100:103], v[132:135], v[14:17]
  s_waitcnt lgkmcnt(3)
  v_mfma_f32_16x16x32_bf16 v[10:13], v[104:107], v[136:139], v[10:13]
  s_waitcnt lgkmcnt(2)
  v_mfma_f32_16x16x32_bf16 v[14:17], v[108:111], v[140:143], v[14:17]
  s_waitcnt lgkmcnt(1)
  v_mfma_f32_16x16x32_bf16 v[10:13], v[112:115], v[144:147], v[10:13]
  s_waitcnt lgkmcnt(0)
  v_mfma_f32_16x16x32_bf16 v[14:17], v[116:119], v[148:151], v[14:17]
  s_nop 7
  v_pk_add_f32 v[10:11], v[10:11], v[14:15]
  v_pk_add_f32 v[12:13], v[12:13], v[16:17]
  v_or_b32 v10, 1, v10
  v_or_b32 v11, 1, v11
  v_or_b32 v12, 1, v12
  v_or_b32 v13, 1, v13
  s_mov_b32 exec_lo, 0x00010001
  s_mov_b32 exec_hi, 0x00010001
  buffer_store_dwordx4 v[10:13], v3, s[16:19], s74 offen sc1
  s_mov_b64 exec, -1
L_AUX_END:
L_END:
  s_endpgm
.section .rodata,"a"
.p2align 6
.amdhsa_kernel adaLN_cond__gqa_block_cached__geglu_ffn__decode_kernel
  .amdhsa_next_free_vgpr 168
  .amdhsa_next_free_sgpr 102
  .amdhsa_accum_offset 168
  .amdhsa_group_segment_fixed_size 0
  .amdhsa_kernarg_size 112
  .amdhsa_user_sgpr_count 2
  .amdhsa_user_sgpr_kernarg_segment_ptr 1
  .amdhsa_system_sgpr_workgroup_id_x 1
.end_amdhsa_kernel
```
